```python
import torch

def _softmax(x, axis=-1):
    return torch.softmax(x, dim=axis)
def _gelu(x):
    return torch.nn.functional.gelu(x, approximate="tanh")
def _silu(x):
    return torch.nn.functional.silu(x)
def _sigmoid(x):
    return torch.sigmoid(x)
def _layernorm(x, axis=-1, eps=1e-5):
    m = x.mean(dim=axis, keepdim=True)
    v = x.var(dim=axis, keepdim=True, unbiased=False)
    return (x - m) / torch.sqrt(v + eps)
def _scatter_add(tgt, idx, src, axis=0):
    return tgt.clone().index_add_(axis, idx, src)
def _segment_sum(src, seg, n):
    out = torch.zeros((n,) + src.shape[1:], dtype=src.dtype)
    return out.index_add_(0, seg, src)
def _pad(x, pw):
    flat = tuple(v for pair in reversed(pw) for v in pair)
    return torch.nn.functional.pad(x, flat)

kernel_name = 'recurrent_scan__ssm_conv_s4d__dense_activation_silu__prompt'

def setup_inputs():

    _w = (lambda a: (lambda t: t.to(torch.bfloat16) if t.is_floating_point() else t)(torch.as_tensor(a)))
    def _A_setup():
        Bsz, L, D, N = 1, 2048, 512, 128
        return {
            "u": _w((lambda *s: torch.randn(*s, dtype=torch.bfloat16) * 0.05)(Bsz, L, D)),
            "log_A_real": _w((lambda *s: torch.randn(*s, dtype=torch.bfloat16) * 6.4)(D, N) * 0.5),
            "A_imag": _w((lambda *s: torch.randn(*s, dtype=torch.bfloat16) * 0.2)(D, N) * 3.14),
            "C_real": _w((lambda *s: torch.randn(*s, dtype=torch.bfloat16) * 0.4)(D, N) / N ** 0.5),
            "C_imag": _w((lambda *s: torch.randn(*s, dtype=torch.bfloat16) * 0.4)(D, N) / N ** 0.5),
            "log_dt": _w((lambda *s: torch.randn(*s, dtype=torch.bfloat16) * 0.2)(D) * 0.5 - 4.0),
            "D_skip": _w((lambda *s: torch.randn(*s, dtype=torch.bfloat16) * 0.2)(D)),
        }
    _A_in = _A_setup()

    def _B_setup():
        B, S, D, F = 1, 2048, 512, 1792
        return {
            "x": _w((lambda *s: torch.randn(*s, dtype=torch.bfloat16) * 0.05)(B, S, D)),
            "w1": _w((lambda *s: torch.randn(*s, dtype=torch.bfloat16) * 0.8)(D, F) * (D ** -0.5)),
            "w2": _w((lambda *s: torch.randn(*s, dtype=torch.bfloat16) * 0.1)(F, D) * (F ** -0.5)),
        }
    _B_in = _B_setup()

    return {
        "A_u": _A_in["u"],
        "A_log_A_real": _A_in["log_A_real"],
        "A_A_imag": _A_in["A_imag"],
        "A_C_real": _A_in["C_real"],
        "A_C_imag": _A_in["C_imag"],
        "A_log_dt": _A_in["log_dt"],
        "A_D_skip": _A_in["D_skip"],
        "B_x": _B_in["x"],
        "B_w1": _B_in["w1"],
        "B_w2": _B_in["w2"],
    }

def reference(A_u, A_log_A_real, A_A_imag, A_C_real, A_C_imag, A_log_dt, A_D_skip, B_x, B_w1, B_w2):
    def _A_ref(u, log_A_real, A_imag, C_real, C_imag, log_dt, D_skip):
        L = u.shape[1]
        dt = torch.exp(log_dt)
        A = -torch.exp(log_A_real) + 1j * A_imag
        C = (C_real + 1j * C_imag) * dt[:, None]
        pos = (lambda x, dt: x.to(dt))(torch.arange(L), log_dt.dtype)
        P = torch.exp((A * dt[:, None])[:, :, None] * pos[None, None, :])
        K = 2.0 * torch.einsum("dn,dnl->dl", C, P).real
        L2 = 2 * L
        u_t = (lambda x, *d: x.permute(*d))(u, 0, 2, 1)
        Kf = (lambda x, *a, **k: torch.fft.rfft(x.float(), *a, **k))(K, L2)
        Uf = (lambda x, *a, **k: torch.fft.rfft(x.float(), *a, **k))(u_t, L2)
        y = (lambda x, *a, **k: torch.fft.irfft(x, *a, **k).to(torch.bfloat16))(Uf * Kf[None, :, :], L2)[:, :, :L]
        y = (lambda x, *d: x.permute(*d))(y, 0, 2, 1)
        return y + u * D_skip[None, None, :]

    def _B_ref(x, w1, w2):
        h = torch.einsum("bsd,df->bsf", x, w1)
        h = _silu(h)
        out = torch.einsum("bsf,fd->bsd", h, w2)
        return out

    x = A_u
    xn = _layernorm(x, axis=-1)
    s = _A_ref(xn, A_log_A_real, A_A_imag, A_C_real, A_C_imag, A_log_dt, A_D_skip)
    g = _silu(_B_ref(xn, B_w1, B_w2))
    return x + s * g
```

```asm
; @launch grid=(256,1,1) block=(512,1,1) lds=163840
.amdgcn_target "amdgcn-amd-amdhsa--gfx950"
.text
.globl recurrent_scan__ssm_conv_s4d__dense_activation_silu__prompt_kernel
.p2align 8
.type recurrent_scan__ssm_conv_s4d__dense_activation_silu__prompt_kernel,@function
recurrent_scan__ssm_conv_s4d__dense_activation_silu__prompt_kernel:
    s_cmp_ge_u32 s2, 256
    s_cbranch_scc1 Lend
    s_load_dwordx2 s[32:33], s[0:1], 0
    s_load_dwordx2 s[44:45], s[0:1], 96
    s_load_dwordx2 s[36:37], s[0:1], 64
    s_load_dwordx8 s[4:11], s[0:1], 8
    s_load_dwordx4 s[12:15], s[0:1], 40
    s_load_dwordx2 s[40:41], s[0:1], 72
    s_load_dwordx2 s[48:49], s[0:1], 80
    s_getpc_b64 s[30:31]
Lpc:
    s_lshr_b32 s54, s2, 3
    v_lshrrev_b32 v14, 5, v0
    s_lshl_b32 s61, s54, 11
    v_lshl_add_u32 v14, v14, 7, s61
    v_min_u32 v14, Lend-Lpc, v14
    global_load_dword v3, v14, s[30:31]
    v_and_b32 v1, 63, v0
    v_lshrrev_b32 v13, 6, v0
    s_and_b32 s53, s2, 7
    v_readfirstlane_b32 s61, v13
    v_lshlrev_b32 v2, 4, v1
    v_mov_b32 v16, 0xc80000
    s_and_b32 s52, s61, 3
    s_lshl_b32 s52, s52, 1
    s_lshr_b32 s73, s61, 2
    s_add_u32 s52, s52, s73
    s_lshl_b32 s57, s53, 5
    s_add_u32 s57, s57, s54
    s_and_b32 s24, s52, 3
    s_lshr_b32 s26, s24, 1
    s_lshl_b32 s62, s57, 2
    s_mov_b32 s34, 0x200000
    s_mov_b32 s35, 0x20000
    s_mov_b32 s46, 0x1400000
    s_mov_b32 s47, 0x20000
    s_lshr_b32 s55, s53, 1
    s_lshl_b32 s55, s55, 2
    s_and_b32 s3, s54, 3
    s_add_u32 s55, s55, s3
    s_lshl_b32 s58, s53, 2
    s_add_u32 s58, s58, s3
    s_lshr_b32 s59, s54, 2
    s_and_b32 s56, s53, 1
    s_mul_i32 s56, s56, 7
    s_min_u32 s3, s59, 6
    s_add_u32 s56, s56, s3
    v_lshrrev_b32 v136, 3, v1
    v_and_b32 v137, 7, v1
    v_lshrrev_b32 v138, 4, v1
    s_cmp_eq_u32 s73, 0
    s_cbranch_scc1 LA0
    s_lshl_b32 s61, s57, 9
    s_lshl_b32 s3, s26, 8
    s_add_u32 s61, s61, s3
    v_lshl_add_u32 v17, v1, 2, s61
    v_xor_b32 v104, v137, v138
    v_lshlrev_b32 v112, 10, v136
    v_lshl_add_u32 v112, v104, 4, v112
    v_xor_b32 v113, 64, v112
    v_add_u32 v113, 7168, v113
    v_and_b32 v104, 15, v1
    v_lshlrev_b32 v105, 1, v138
    v_xor_b32 v104, v104, v105
    v_mul_u32_u24 v114, 3584, v138
    v_lshl_add_u32 v114, v104, 4, v114
    v_xor_b32 v104, 8, v104
    v_mul_u32_u24 v115, 3584, v138
    v_lshl_add_u32 v115, v104, 4, v115
    v_add_u32 v115, 27648, v115
    s_lshl_b32 s16, s55, 17
    s_lshl_b32 s3, s52, 14
    s_add_u32 s16, s16, s3
    s_lshr_b32 s3, s52, 1
    s_lshl_b32 s3, s3, 4
    s_add_u32 s3, s3, 4
    s_mul_i32 s17, s3, 3584
    s_lshl_b32 s3, s56, 8
    s_add_u32 s17, s17, s3
    s_mul_i32 s18, s52, 4096
    s_cmp_eq_u32 s59, 7
    s_cselect_b32 s38, 0, 0x1c0800
    s_mov_b32 s39, 0x20000
    s_and_b32 s61, s54, 3
    s_lshl_b32 s61, s61, 1
    s_add_u32 s61, s61, s59
    s_add_u32 s61, s61, 7
    s_lshl_b32 s2, s61, 7
    s_waitcnt lgkmcnt(0)
    buffer_load_dword v64, v16, s[44:47], 0 offen sc1
    s_load_dword s28, s[12:13], s62
    s_load_dword s29, s[14:15], s62
    global_load_dword v28, v17, s[4:5]
    global_load_dword v29, v17, s[6:7]
    global_load_dword v30, v17, s[8:9]
    global_load_dword v31, v17, s[10:11]
    s_sub_u32 s36, s36, 2048
    s_subb_u32 s37, s37, 0
    s_mov_b32 s0, s2
    s_barrier
    s_add_u32 s2, s2, 128
    s_and_b32 s2, s2, 1023
    s_add_u32 m0, s18, 32768
    s_add_u32 s5, s16, s2
    buffer_load_dwordx4 v112, s[32:35], s5 offen lds
    buffer_load_dwordx4 v113, s[32:35], s5 offen offset:1024 lds
    s_add_u32 m0, s18, 0x7000
    s_sub_u32 s5, s5, 16384
    buffer_load_dwordx4 v112, s[32:35], s5 offen lds
    buffer_load_dwordx4 v113, s[32:35], s5 offen offset:1024 lds
    s_add_u32 s0, s0, 128
    s_and_b32 s0, s0, 1023
    s_mul_i32 s1, s0, 1792
    s_add_u32 m0, s18, 32768
    s_add_u32 s1, s1, s17
    buffer_load_dwordx4 v114, s[36:39], s1 offen offset:2048  lds
    buffer_load_dwordx4 v115, s[36:39], s1 offen offset:3072  lds
    s_add_u32 m0, s18, 0x7000
    s_sub_u32 s1, s1, 14336
    buffer_load_dwordx4 v114, s[36:39], s1 offen offset:2048  lds
    buffer_load_dwordx4 v115, s[36:39], s1 offen offset:3072  lds
    s_branch Lcs
LA0:
    s_lshl_b32 s25, s57, 3
    s_add_u32 s25, s25, s52
    s_lshl_b32 s27, s25, 10
    s_waitcnt lgkmcnt(0)
    buffer_load_dword v64, v16, s[44:47], 0 offen sc1
    s_load_dword s28, s[12:13], s62
    s_load_dword s29, s[14:15], s62
    buffer_load_dwordx4 v[28:31], v2, s[32:35], s27 offen
    buffer_load_dwordx4 v[60:63], v2, s[32:35], s27 offen offset:1024
    s_barrier
Lcs:
    s_mov_b32 s50, 0x200000
    s_mov_b32 s51, 0x20000
    s_mov_b32 s42, 0x1c0000
    s_mov_b32 s43, 0x20000
    v_bfe_u32 v139, v1, 2, 2
    v_and_b32 v140, 3, v1
    v_and_b32 v141, 15, v1
    v_lshlrev_b32 v104, 1, v138
    v_xor_b32 v104, v137, v104
    v_lshlrev_b32 v16, 10, v136
    v_lshl_add_u32 v16, v104, 4, v16
    v_add_u32 v17, 7168, v16
    v_add_u32 v18, 14336, v16
    v_add_u32 v19, 21504, v16
    s_lshl_b32 s23, s52, 12
    s_add_u32 s23, s23, 65536
    v_lshl_add_u32 v104, v138, 2, v139
    v_bfe_u32 v105, v104, 1, 2
    v_lshlrev_b32 v106, 3, v140
    v_lshl_add_u32 v106, v104, 7, v106
    v_lshl_add_u32 v106, v105, 5, v106
    v_add_u32 v20, s23, v106
    v_xor_b32 v21, 32, v20
    v_xor_b32 v22, 64, v20
    v_xor_b32 v23, 96, v20
    s_mul_i32 s61, s58, 224
    s_lshl_b32 s19, s61, 15
    s_lshl_b32 s3, s59, 7
    s_sub_u32 s19, s3, s19
    s_mul_i32 s3, s52, 7
    s_add_u32 s61, s61, s3
    s_lshl_b32 s61, s61, 10
    s_and_b32 s3, s54, 3
    s_lshl_b32 s3, s3, 1
    s_add_u32 s3, s3, s59
    s_cmp_ge_u32 s3, 7
    s_cselect_b32 s7, 7, 0
    s_sub_u32 s3, s3, s7
    s_lshl_b32 s3, s3, 10
    s_add_u32 s64, s61, s3
    s_add_u32 s7, s61, 7168
    s_add_u32 s65, s64, 1024
    s_cmp_eq_u32 s65, s7
    s_cselect_b32 s65, s61, s65
    s_add_u32 s66, s65, 1024
    s_cmp_eq_u32 s66, s7
    s_cselect_b32 s66, s61, s66
    s_add_u32 s67, s66, 1024
    s_cmp_eq_u32 s67, s7
    s_cselect_b32 s67, s61, s67
    s_add_u32 s68, s67, 1024
    s_cmp_eq_u32 s68, s7
    s_cselect_b32 s68, s61, s68
    s_add_u32 s69, s68, 1024
    s_cmp_eq_u32 s69, s7
    s_cselect_b32 s69, s61, s69
    s_add_u32 s70, s69, 1024
    s_cmp_eq_u32 s70, s7
    s_cselect_b32 s70, s61, s70
    v_add_u32 v13, 57344, v2
    v_add_u32 v14, 114688, v2
    v_add_u32 v15, 172032, v2
    s_mul_i32 s3, s52, 7
    s_lshr_b32 s3, s3, 1
    s_lshl_b32 s61, s58, 5
    s_add_u32 s61, s61, s3
    s_lshl_b32 s61, s61, 4
    s_add_u32 s61, s61, 12713984
    v_lshl_add_u32 v11, v140, 4, s61
    s_lshl_b32 s3, s73, 8
    s_mul_i32 s61, s26, 16640
    v_not_b32 v104, v141
    v_and_b32 v104, 3, v104
    v_or_b32 v105, 3, v141
    v_lshlrev_b32 v106, 3, v138
    v_sub_u32 v105, v106, v105
    v_mul_u32_u24 v104, 4160, v104
    v_lshl_add_u32 v105, v105, 1, v104
    s_sub_u32 s61, s61, s3
    s_add_u32 s61, s61, 9502
    v_add_u32 v5, s61, v105
    v_lshlrev_b32 v104, 5, v141
    v_lshl_add_u32 v105, v138, 4, v104
    s_mul_i32 s7, s26, 4608
    s_sub_u32 s61, s7, s3
    s_add_u32 s61, s61, 288
    v_add_u32 v6, s61, v105
    s_lshl_b32 s3, s73, 11
    s_add_u32 s61, s7, s3
    s_add_u32 s61, s61, 512
    v_lshl_add_u32 v7, v1, 3, s61
    s_waitcnt lgkmcnt(0)
    s_lshr_b32 s15, s52, 2
    s_lshl_b32 s13, s52, 12
    v_mul_u32_u24 v105, 320, v138
    v_lshl_add_u32 v105, v141, 4, v105
    s_mul_i32 s61, s52, 2560
    s_add_u32 s61, s61, 45056
    v_add_u32 v9, s61, v105
    v_add_u32 v8, s13, v105
    v_mul_u32_u24 v105, 320, v140
    v_lshrrev_b32 v106, 2, v1
    v_lshl_add_u32 v105, v106, 4, v105
    v_add_u32 v12, s13, v105
    s_xor_b32 s61, s52, 1
    s_mul_i32 s61, s61, 2560
    s_add_u32 s61, s61, 45056
    v_add_u32 v10, s61, v105
    s_lshl_b32 s61, s57, 1
    s_add_u32 s61, s61, s26
    s_lshl_b32 s72, s61, 13
    s_lshl_b32 s3, s73, 12
    s_add_u32 s72, s72, s3
    s_add_u32 s72, s72, 16777216
    s_lshl_b32 s61, s26, 4
    s_lshr_b32 s28, s28, s61
    s_lshl_b32 s28, s28, 16
    s_lshr_b32 s20, s29, s61
    s_lshl_b32 s20, s20, 16
    s_cmp_eq_u32 s73, 0
    s_cbranch_scc0 LB
    s_mul_i32 s61, s52, 1088
    s_add_u32 s61, s61, 0
    v_add_u32 v123, s61, v2
    s_lshl_b32 s25, s25, 3
    s_add_u32 s25, s25, 12582912
    s_lshl_b32 s61, s55, 10
    s_lshl_b32 s3, s26, 9
    s_add_u32 s61, s61, s3
    s_add_u32 s61, s61, 12582912
    v_lshl_add_u32 v121, v141, 3, s61
    v_lshlrev_b32 v122, 4, v138
    v_add_u32 v122, 60432, v122
    s_lshl_b32 s27, s55, 3
    s_lshl_b32 s3, s26, 2
    s_add_u32 s27, s27, s3
    s_mul_i32 s27, s27, 56
    s_lshl_b32 s28, s56, 1
    s_add_u32 s28, s28, s15
    s_lshl_b32 s61, s28, 1
    s_add_u32 s27, s27, s61
    s_add_u32 s11, s27, s26
    s_lshl_b32 s11, s11, 10
    s_xor_b32 s12, s11, 1024
    s_lshl_b32 s4, s55, 1
    s_add_u32 s4, s4, s26
    s_lshl_b32 s4, s4, 5
    s_add_u32 s4, s4, s28
    s_lshl_b32 s4, s4, 4
    s_add_u32 s4, s4, 12713984
    s_lshr_b32 s61, s52, 1
    s_lshl_b32 s9, s57, 14
    s_lshl_b32 s3, s61, 11
    s_add_u32 s9, s9, s3
    s_add_u32 s9, s9, 8388608
    s_add_u32 s10, s9, 8192
    v_mul_u32_u24 v124, 1088, v139
    v_lshl_add_u32 v124, v138, 5, v124
    v_lshl_add_u32 v124, v140, 3, v124
    s_lshl_b32 s61, s61, 8
    s_add_u32 s61, s61, 0
    v_add_u32 v124, s61, v124
    v_lshrrev_b32 v104, 1, v141
    v_xor_b32 v104, v138, v104
    v_lshlrev_b32 v24, 7, v141
    v_lshl_add_u32 v24, v104, 4, v24
    s_mul_i32 s61, s26, 16384
    v_add_u32 v24, s61, v24
    v_xor_b32 v25, 64, v24
    v_bfe_u32 v104, v1, 2, 3
    v_mul_u32_u24 v104, 288, v104
    v_lshrrev_b32 v105, 5, v1
    v_lshl_add_u32 v104, v105, 13, v104
    v_lshl_add_u32 v104, v140, 3, v104
    v_add_u32 v104, 2048, v104
    s_lshl_b32 s61, s52, 5
    v_xor_b32 v26, s61, v104
    v_xor_b32 v27, 32, v26
    v_xor_b32 v120, 64, v26
    v_xor_b32 v126, 96, v26
    s_lshl_b32 s61, s52, 6
    v_add_u32 v122, s61, v122
    s_xor_b32 s3, s61, 128
    s_sub_u32 s3, s3, s61
    v_add_u32 v125, s3, v122
    v_mov_b32 v116, 0x3f803f80
    v_mov_b32 v117, 0x3f803f80
    v_mov_b32 v118, 0x3f803f80
    v_mov_b32 v119, 0x3f803f80
    s_waitcnt vmcnt(0)
    v_readfirstlane_b32 s60, v64
    v_mov_b32 v3, 0
    s_mul_i32 s60, s60, 0x9E3779B1
    s_add_u32 s60, s60, 0x7F4A7C15
    v_mov_b32 v4, s60
    v_readfirstlane_b32 s3, v28
    v_readfirstlane_b32 s7, v60
    v_lshlrev_b32 v34, 16, v28
    v_lshlrev_b32 v66, 16, v60
    v_and_b32 v35, 0xffff0000, v28
    v_and_b32 v67, 0xffff0000, v60
    v_lshlrev_b32 v36, 16, v29
    v_lshlrev_b32 v68, 16, v61
    v_and_b32 v37, 0xffff0000, v29
    v_and_b32 v69, 0xffff0000, v61
    v_lshlrev_b32 v38, 16, v30
    v_lshlrev_b32 v70, 16, v62
    v_and_b32 v39, 0xffff0000, v30
    v_and_b32 v71, 0xffff0000, v62
    v_lshlrev_b32 v40, 16, v31
    v_lshlrev_b32 v72, 16, v63
    v_and_b32 v41, 0xffff0000, v31
    v_and_b32 v73, 0xffff0000, v63
    s_lshl_b32 s3, s3, 16
    s_lshl_b32 s7, s7, 16
    s_xor_b32 s3, s3, 0x80000000
    s_xor_b32 s7, s7, 0x80000000
    v_mov_b32 v46, s3
    v_mov_b32 v78, s7
    v_pk_add_f32 v[48:49], v[34:35], v[46:47] op_sel_hi:[1,0]
    v_pk_add_f32 v[80:81], v[66:67], v[78:79] op_sel_hi:[1,0]
    v_pk_add_f32 v[50:51], v[36:37], v[46:47] op_sel_hi:[1,0]
    v_pk_add_f32 v[82:83], v[68:69], v[78:79] op_sel_hi:[1,0]
    v_pk_add_f32 v[52:53], v[38:39], v[46:47] op_sel_hi:[1,0]
    v_pk_add_f32 v[84:85], v[70:71], v[78:79] op_sel_hi:[1,0]
    v_pk_add_f32 v[54:55], v[40:41], v[46:47] op_sel_hi:[1,0]
    v_pk_add_f32 v[86:87], v[72:73], v[78:79] op_sel_hi:[1,0]
    v_pk_add_f32 v[42:43], v[48:49], v[50:51]
    v_pk_add_f32 v[74:75], v[80:81], v[82:83]
    v_pk_mul_f32 v[44:45], v[48:49], v[48:49]
    v_pk_mul_f32 v[76:77], v[80:81], v[80:81]
    v_pk_add_f32 v[42:43], v[42:43], v[52:53]
    v_pk_add_f32 v[74:75], v[74:75], v[84:85]
    v_pk_fma_f32 v[44:45], v[50:51], v[50:51], v[44:45]
    v_pk_fma_f32 v[76:77], v[82:83], v[82:83], v[76:77]
    v_pk_add_f32 v[42:43], v[42:43], v[54:55]
    v_pk_add_f32 v[74:75], v[74:75], v[86:87]
    v_pk_fma_f32 v[44:45], v[52:53], v[52:53], v[44:45]
    v_pk_fma_f32 v[76:77], v[84:85], v[84:85], v[76:77]
    v_add_f32 v42, v42, v43
    v_add_f32 v74, v74, v75
    v_pk_fma_f32 v[44:45], v[54:55], v[54:55], v[44:45]
    v_pk_fma_f32 v[76:77], v[86:87], v[86:87], v[76:77]
    v_add_f32 v44, v44, v45
    v_add_f32 v76, v76, v77
    v_add_f32_dpp v42, v42, v42 row_shr:1 row_mask:0xf bank_mask:0xf
    v_add_f32_dpp v74, v74, v74 row_shr:1 row_mask:0xf bank_mask:0xf
    v_add_f32_dpp v44, v44, v44 row_shr:1 row_mask:0xf bank_mask:0xf
    v_add_f32_dpp v76, v76, v76 row_shr:1 row_mask:0xf bank_mask:0xf
    v_add_f32_dpp v42, v42, v42 row_shr:2 row_mask:0xf bank_mask:0xf
    v_add_f32_dpp v74, v74, v74 row_shr:2 row_mask:0xf bank_mask:0xf
    v_add_f32_dpp v44, v44, v44 row_shr:2 row_mask:0xf bank_mask:0xf
    v_add_f32_dpp v76, v76, v76 row_shr:2 row_mask:0xf bank_mask:0xf
    v_add_f32_dpp v42, v42, v42 row_shr:4 row_mask:0xf bank_mask:0xf
    v_add_f32_dpp v74, v74, v74 row_shr:4 row_mask:0xf bank_mask:0xf
    v_add_f32_dpp v44, v44, v44 row_shr:4 row_mask:0xf bank_mask:0xf
    v_add_f32_dpp v76, v76, v76 row_shr:4 row_mask:0xf bank_mask:0xf
    v_add_f32_dpp v42, v42, v42 row_shr:8 row_mask:0xf bank_mask:0xf
    v_add_f32_dpp v74, v74, v74 row_shr:8 row_mask:0xf bank_mask:0xf
    v_add_f32_dpp v44, v44, v44 row_shr:8 row_mask:0xf bank_mask:0xf
    v_add_f32_dpp v76, v76, v76 row_shr:8 row_mask:0xf bank_mask:0xf
    v_add_f32_dpp v42, v42, v42 row_bcast:15 row_mask:0xa bank_mask:0xf
    v_add_f32_dpp v74, v74, v74 row_bcast:15 row_mask:0xa bank_mask:0xf
    v_add_f32_dpp v44, v44, v44 row_bcast:15 row_mask:0xa bank_mask:0xf
    v_add_f32_dpp v76, v76, v76 row_bcast:15 row_mask:0xa bank_mask:0xf
    v_add_f32_dpp v42, v42, v42 row_bcast:31 row_mask:0xc bank_mask:0xf
    v_add_f32_dpp v74, v74, v74 row_bcast:31 row_mask:0xc bank_mask:0xf
    v_add_f32_dpp v44, v44, v44 row_bcast:31 row_mask:0xc bank_mask:0xf
    v_add_f32_dpp v76, v76, v76 row_bcast:31 row_mask:0xc bank_mask:0xf
    v_readlane_b32 s61, v42, 63
    v_readlane_b32 s5, v74, 63
    v_readlane_b32 s62, v44, 63
    v_readlane_b32 s63, v76, 63
    v_mov_b32 v97, s60
    v_mov_b32 v99, s60
    v_mov_b32 v42, 0x3b000000
    v_mov_b32 v74, 0x3b000000
    v_mul_f32 v44, s62, v42
    v_mul_f32 v76, s63, v74
    v_mul_f32 v42, s61, v42
    v_mul_f32 v74, s5, v74
    v_fma_f32 v44, -v42, v42, v44
    v_fma_f32 v76, -v74, v74, v76
    v_sub_f32 v42, v46, v42
    v_sub_f32 v74, v78, v74
    v_max_f32 v44, 0, v44
    v_max_f32 v76, 0, v76
    v_cvt_pk_bf16_f32 v44, v44, v44
    v_cvt_pk_bf16_f32 v76, v76, v76
    v_and_b32 v44, 0xffff0000, v44
    v_and_b32 v76, 0xffff0000, v76
    v_add_f32 v44, 0x3727c5ac, v44
    v_add_f32 v76, 0x3727c5ac, v76
    v_cvt_pk_bf16_f32 v44, v44, v44
    v_cvt_pk_bf16_f32 v76, v76, v76
    v_and_b32 v44, 0xffff0000, v44
    v_and_b32 v76, 0xffff0000, v76
    v_sqrt_f32 v44, v44
    v_sqrt_f32 v76, v76
    v_cvt_pk_bf16_f32 v96, v42, v44
    v_cvt_pk_bf16_f32 v98, v74, v76
    v_lshlrev_b32 v42, 16, v96
    v_lshlrev_b32 v74, 16, v98
    v_and_b32 v44, 0xffff0000, v96
    v_and_b32 v76, 0xffff0000, v98
    v_rcp_f32 v44, v44
    v_rcp_f32 v76, v76
    v_pk_add_f32 v[34:35], v[34:35], v[42:43] op_sel_hi:[1,0]
    v_pk_add_f32 v[66:67], v[66:67], v[74:75] op_sel_hi:[1,0]
    v_pk_add_f32 v[36:37], v[36:37], v[42:43] op_sel_hi:[1,0]
    v_pk_add_f32 v[68:69], v[68:69], v[74:75] op_sel_hi:[1,0]
    v_pk_add_f32 v[38:39], v[38:39], v[42:43] op_sel_hi:[1,0]
    v_pk_add_f32 v[70:71], v[70:71], v[74:75] op_sel_hi:[1,0]
    v_pk_add_f32 v[40:41], v[40:41], v[42:43] op_sel_hi:[1,0]
    v_pk_add_f32 v[72:73], v[72:73], v[74:75] op_sel_hi:[1,0]
    v_cvt_pk_bf16_f32 v28, v34, v35
    v_cvt_pk_bf16_f32 v60, v66, v67
    v_cvt_pk_bf16_f32 v29, v36, v37
    v_cvt_pk_bf16_f32 v61, v68, v69
    v_cvt_pk_bf16_f32 v30, v38, v39
    v_cvt_pk_bf16_f32 v62, v70, v71
    v_cvt_pk_bf16_f32 v31, v40, v41
    v_cvt_pk_bf16_f32 v63, v72, v73
    v_lshlrev_b32 v34, 16, v28
    v_lshlrev_b32 v66, 16, v60
    v_and_b32 v35, 0xffff0000, v28
    v_and_b32 v67, 0xffff0000, v60
    v_lshlrev_b32 v36, 16, v29
    v_lshlrev_b32 v68, 16, v61
    v_and_b32 v37, 0xffff0000, v29
    v_and_b32 v69, 0xffff0000, v61
    v_lshlrev_b32 v38, 16, v30
    v_lshlrev_b32 v70, 16, v62
    v_and_b32 v39, 0xffff0000, v30
    v_and_b32 v71, 0xffff0000, v62
    v_lshlrev_b32 v40, 16, v31
    v_lshlrev_b32 v72, 16, v63
    v_and_b32 v41, 0xffff0000, v31
    v_and_b32 v73, 0xffff0000, v63
    v_pk_mul_f32 v[34:35], v[34:35], v[44:45] op_sel_hi:[1,0]
    v_pk_mul_f32 v[66:67], v[66:67], v[76:77] op_sel_hi:[1,0]
    v_pk_mul_f32 v[36:37], v[36:37], v[44:45] op_sel_hi:[1,0]
    v_pk_mul_f32 v[68:69], v[68:69], v[76:77] op_sel_hi:[1,0]
    v_pk_mul_f32 v[38:39], v[38:39], v[44:45] op_sel_hi:[1,0]
    v_pk_mul_f32 v[70:71], v[70:71], v[76:77] op_sel_hi:[1,0]
    v_pk_mul_f32 v[40:41], v[40:41], v[44:45] op_sel_hi:[1,0]
    v_pk_mul_f32 v[72:73], v[72:73], v[76:77] op_sel_hi:[1,0]
    v_cvt_pk_bf16_f32 v28, v34, v35
    v_cvt_pk_bf16_f32 v60, v66, v67
    v_cvt_pk_bf16_f32 v29, v36, v37
    v_cvt_pk_bf16_f32 v61, v68, v69
    v_cvt_pk_bf16_f32 v30, v38, v39
    v_cvt_pk_bf16_f32 v62, v70, v71
    v_cvt_pk_bf16_f32 v31, v40, v41
    v_cvt_pk_bf16_f32 v63, v72, v73
    ds_write_b128 v123, v[28:31] offset:0
    ds_write_b128 v123, v[60:63] offset:1088
    s_mov_b64 exec, 1
    buffer_store_dwordx4 v[96:99], v3, s[44:47], s25 offen sc1
    s_mov_b64 exec, -1
    s_waitcnt lgkmcnt(0)
    s_barrier
    ds_read_b64_tr_b16 a[64:65], v26 offset:32768
    ds_read_b64_tr_b16 a[66:67], v26 offset:36864
    ds_read_b128 a[32:35], v24 offset:32768
    ds_read_b128 a[36:39], v24 offset:36864
    ds_read_b128 a[40:43], v24 offset:40960
    ds_read_b128 a[44:47], v24 offset:45056
    ds_read_b64_tr_b16 a[68:69], v27 offset:32768
    ds_read_b64_tr_b16 a[70:71], v27 offset:36864
    ds_read_b64_tr_b16 a[72:73], v120 offset:32768
    ds_read_b64_tr_b16 a[74:75], v120 offset:36864
    ds_read_b64_tr_b16 a[76:77], v126 offset:32768
    ds_read_b64_tr_b16 a[78:79], v126 offset:36864
    s_waitcnt lgkmcnt(4)
    v_mfma_f32_16x16x32_bf16 v[92:95], a[64:67], v[116:119], 0
    v_mfma_f32_16x16x32_bf16 v[28:31], a[64:67], a[32:35], 0
    ds_read_b64_tr_b16 v[136:137], v124 offset:0
    ds_read_b64_tr_b16 v[138:139], v124 offset:4352
    v_mfma_f32_16x16x32_bf16 v[32:35], a[64:67], a[36:39], 0
    ds_read_b64_tr_b16 v[140:141], v124 offset:128
    ds_read_b64_tr_b16 v[142:143], v124 offset:4480
    v_mfma_f32_16x16x32_bf16 v[36:39], a[64:67], a[40:43], 0
    ds_read_b64_tr_b16 a[80:81], v26 offset:49152
    v_mfma_f32_16x16x32_bf16 v[40:43], a[64:67], a[44:47], 0
    ds_read_b64_tr_b16 a[82:83], v26 offset:53248
    v_mfma_f32_16x16x32_bf16 v[96:99], a[68:71], v[116:119], 0
    ds_read_b128 a[48:51], v25 offset:32768
    v_mfma_f32_16x16x32_bf16 v[44:47], a[68:71], a[32:35], 0
    ds_read_b128 a[52:55], v25 offset:36864
    v_mfma_f32_16x16x32_bf16 v[48:51], a[68:71], a[36:39], 0
    ds_read_b128 a[56:59], v25 offset:40960
    v_mfma_f32_16x16x32_bf16 v[52:55], a[68:71], a[40:43], 0
    ds_read_b128 a[60:63], v25 offset:45056
    v_mfma_f32_16x16x32_bf16 v[56:59], a[68:71], a[44:47], 0
    ds_read_b64_tr_b16 a[84:85], v27 offset:49152
    s_waitcnt lgkmcnt(11)
    v_mfma_f32_16x16x32_bf16 v[60:63], a[72:75], a[32:35], 0
    ds_read_b64_tr_b16 a[86:87], v27 offset:53248
    v_mfma_f32_16x16x32_bf16 v[64:67], a[72:75], a[36:39], 0
    ds_read_b64_tr_b16 a[88:89], v120 offset:49152
    v_mfma_f32_16x16x32_bf16 v[68:71], a[72:75], a[40:43], 0
    ds_read_b64_tr_b16 a[90:91], v120 offset:53248
    v_mfma_f32_16x16x32_bf16 v[72:75], a[72:75], a[44:47], 0
    ds_read_b64_tr_b16 a[92:93], v126 offset:49152
    v_mfma_f32_16x16x32_bf16 v[76:79], a[76:79], a[32:35], 0
    ds_read_b64_tr_b16 a[94:95], v126 offset:53248
    v_mfma_f32_16x16x32_bf16 v[80:83], a[76:79], a[36:39], 0
    s_mul_i32 s61, s57, 7168
    s_mul_i32 s3, s52, 896
    s_add_u32 s61, s61, s3
    v_lshlrev_b32 v127, 7, v1
    s_mov_b64 exec, 0x3fff
    buffer_load_dword v127, v127, s[40:43], s61 offen
    s_mov_b64 exec, -1
    v_mfma_f32_16x16x32_bf16 v[84:87], a[76:79], a[40:43], 0
    v_mfma_f32_16x16x32_bf16 v[88:91], a[76:79], a[44:47], 0
    s_barrier
    s_waitcnt lgkmcnt(4)
    v_mfma_f32_16x16x32_bf16 v[92:95], a[80:83], v[116:119], v[92:95]
    v_add_u32 v24, 0x10000, v24
    v_mfma_f32_16x16x32_bf16 v[28:31], a[80:83], a[48:51], v[28:31]
    v_add_u32 v25, 0x10000, v25
    v_mfma_f32_16x16x32_bf16 v[32:35], a[80:83], a[52:55], v[32:35]
    v_add_u32 v26, 0x10000, v26
    v_mfma_f32_16x16x32_bf16 v[36:39], a[80:83], a[56:59], v[36:39]
    v_add_u32 v27, 0x10000, v27
    v_mfma_f32_16x16x32_bf16 v[40:43], a[80:83], a[60:63], v[40:43]
    v_add_u32 v120, 0x10000, v120
    v_mfma_f32_16x16x32_bf16 v[96:99], a[84:87], v[116:119], v[96:99]
    v_add_u32 v126, 0x10000, v126
    v_mfma_f32_16x16x32_bf16 v[44:47], a[84:87], a[48:51], v[44:47]
    ds_read_b64_tr_b16 a[64:65], v26 offset:0
    v_mfma_f32_16x16x32_bf16 v[48:51], a[84:87], a[52:55], v[48:51]
    ds_read_b64_tr_b16 a[66:67], v26 offset:4096
    ds_read_b128 a[32:35], v24 offset:0
    v_mfma_f32_16x16x32_bf16 v[52:55], a[84:87], a[56:59], v[52:55]
    ds_read_b128 a[36:39], v24 offset:4096
    v_mfma_f32_16x16x32_bf16 v[56:59], a[84:87], a[60:63], v[56:59]
    ds_read_b128 a[40:43], v24 offset:8192
    s_waitcnt lgkmcnt(5)
    v_mfma_f32_16x16x32_bf16 v[60:63], a[88:91], a[48:51], v[60:63]
    ds_read_b128 a[44:47], v24 offset:12288
    v_mfma_f32_16x16x32_bf16 v[64:67], a[88:91], a[52:55], v[64:67]
    ds_read_b64_tr_b16 a[68:69], v27 offset:0
    v_mfma_f32_16x16x32_bf16 v[68:71], a[88:91], a[56:59], v[68:71]
    ds_read_b64_tr_b16 a[70:71], v27 offset:4096
    v_mfma_f32_16x16x32_bf16 v[72:75], a[88:91], a[60:63], v[72:75]
    ds_read_b64_tr_b16 a[72:73], v120 offset:0
    v_mfma_f32_16x16x32_bf16 v[76:79], a[92:95], a[48:51], v[76:79]
    ds_read_b64_tr_b16 a[74:75], v120 offset:4096
    v_mfma_f32_16x16x32_bf16 v[80:83], a[92:95], a[52:55], v[80:83]
    ds_read_b64_tr_b16 a[76:77], v126 offset:0
    ds_read_b64_tr_b16 a[78:79], v126 offset:4096
    v_mfma_f32_16x16x32_bf16 v[84:87], a[92:95], a[56:59], v[84:87]
    v_mfma_f32_16x16x32_bf16 v[88:91], a[92:95], a[60:63], v[88:91]
    s_waitcnt lgkmcnt(4)
    v_mfma_f32_16x16x32_bf16 v[92:95], a[64:67], v[116:119], v[92:95]
    ds_read_b64_tr_b16 a[80:81], v26 offset:16384
    v_mfma_f32_16x16x32_bf16 v[28:31], a[64:67], a[32:35], v[28:31]
    ds_read_b64_tr_b16 a[82:83], v26 offset:20480
    ds_read_b128 a[48:51], v25 offset:0
    v_mfma_f32_16x16x32_bf16 v[32:35], a[64:67], a[36:39], v[32:35]
    ds_read_b128 a[52:55], v25 offset:4096
    v_mfma_f32_16x16x32_bf16 v[36:39], a[64:67], a[40:43], v[36:39]
    ds_read_b128 a[56:59], v25 offset:8192
    ds_read_b128 a[60:63], v25 offset:12288
    v_mfma_f32_16x16x32_bf16 v[40:43], a[64:67], a[44:47], v[40:43]
    ds_read_b64_tr_b16 a[84:85], v27 offset:16384
    ds_read_b64_tr_b16 a[86:87], v27 offset:20480
    v_mfma_f32_16x16x32_bf16 v[96:99], a[68:71], v[116:119], v[96:99]
    ds_read_b64_tr_b16 a[88:89], v120 offset:16384
    v_mfma_f32_16x16x32_bf16 v[44:47], a[68:71], a[32:35], v[44:47]
    ds_read_b64_tr_b16 a[90:91], v120 offset:20480
    ds_read_b64_tr_b16 a[92:93], v126 offset:16384
    v_mfma_f32_16x16x32_bf16 v[48:51], a[68:71], a[36:39], v[48:51]
    ds_read_b64_tr_b16 a[94:95], v126 offset:20480
    v_mfma_f32_16x16x32_bf16 v[52:55], a[68:71], a[40:43], v[52:55]
    s_mov_b32 vcc_lo, 0xcccccccc
    s_mov_b32 vcc_hi, 0xcccccccc
    v_mfma_f32_16x16x32_bf16 v[56:59], a[68:71], a[44:47], v[56:59]
    v_mov_b32_dpp v100, v138 quad_perm:[0,1,0,1] row_mask:0xf bank_mask:0xf
    v_cndmask_b32 v100, v136, v100, vcc
    v_cndmask_b32_dpp v104, v136, v138, vcc quad_perm:[2,3,2,3] row_mask:0xf bank_mask:0xf
    s_waitcnt lgkmcnt(12)
    v_mfma_f32_16x16x32_bf16 v[60:63], a[72:75], a[32:35], v[60:63]
    v_mov_b32 v101, v4
    v_mov_b32 v105, v4
    v_mfma_f32_16x16x32_bf16 v[64:67], a[72:75], a[36:39], v[64:67]
    v_mov_b32_dpp v102, v139 quad_perm:[0,1,0,1] row_mask:0xf bank_mask:0xf
    v_cndmask_b32 v102, v137, v102, vcc
    v_cndmask_b32_dpp v106, v137, v139, vcc quad_perm:[2,3,2,3] row_mask:0xf bank_mask:0xf
    v_mfma_f32_16x16x32_bf16 v[68:71], a[72:75], a[40:43], v[68:71]
    v_mov_b32 v103, v4
    v_mov_b32 v107, v4
    v_mov_b32_dpp v108, v142 quad_perm:[0,1,0,1] row_mask:0xf bank_mask:0xf
    v_cndmask_b32 v108, v140, v108, vcc
    v_mfma_f32_16x16x32_bf16 v[72:75], a[72:75], a[44:47], v[72:75]
    v_cndmask_b32_dpp v112, v140, v142, vcc quad_perm:[2,3,2,3] row_mask:0xf bank_mask:0xf
    v_mfma_f32_16x16x32_bf16 v[76:79], a[76:79], a[32:35], v[76:79]
    v_mov_b32 v109, v4
    v_mov_b32 v113, v4
    v_mov_b32_dpp v110, v143 quad_perm:[0,1,0,1] row_mask:0xf bank_mask:0xf
    v_cndmask_b32 v110, v141, v110, vcc
    v_mfma_f32_16x16x32_bf16 v[80:83], a[76:79], a[36:39], v[80:83]
    v_cndmask_b32_dpp v114, v141, v143, vcc quad_perm:[2,3,2,3] row_mask:0xf bank_mask:0xf
    v_mov_b32 v111, v4
    v_mov_b32 v115, v4
    v_mfma_f32_16x16x32_bf16 v[84:87], a[76:79], a[40:43], v[84:87]
    v_mfma_f32_16x16x32_bf16 v[88:91], a[76:79], a[44:47], v[88:91]
    s_barrier
    s_waitcnt lgkmcnt(4)
    v_mfma_f32_16x16x32_bf16 v[92:95], a[80:83], v[116:119], v[92:95]
    v_mfma_f32_16x16x32_bf16 v[28:31], a[80:83], a[48:51], v[28:31]
    ds_read_b64_tr_b16 a[64:65], v26 offset:32768
    v_mfma_f32_16x16x32_bf16 v[32:35], a[80:83], a[52:55], v[32:35]
    ds_read_b64_tr_b16 a[66:67], v26 offset:36864
    v_mfma_f32_16x16x32_bf16 v[36:39], a[80:83], a[56:59], v[36:39]
    ds_read_b128 a[32:35], v24 offset:32768
    v_mfma_f32_16x16x32_bf16 v[40:43], a[80:83], a[60:63], v[40:43]
    v_mfma_f32_16x16x32_bf16 v[96:99], a[84:87], v[116:119], v[96:99]
    ds_read_b128 a[36:39], v24 offset:36864
    v_mfma_f32_16x16x32_bf16 v[44:47], a[84:87], a[48:51], v[44:47]
    ds_read_b128 a[40:43], v24 offset:40960
    v_mfma_f32_16x16x32_bf16 v[48:51], a[84:87], a[52:55], v[48:51]
    ds_read_b128 a[44:47], v24 offset:45056
    v_mfma_f32_16x16x32_bf16 v[52:55], a[84:87], a[56:59], v[52:55]
    v_mfma_f32_16x16x32_bf16 v[56:59], a[84:87], a[60:63], v[56:59]
    ds_read_b64_tr_b16 a[68:69], v27 offset:32768
    s_waitcnt lgkmcnt(7)
    v_mfma_f32_16x16x32_bf16 v[60:63], a[88:91], a[48:51], v[60:63]
    ds_read_b64_tr_b16 a[70:71], v27 offset:36864
    v_mfma_f32_16x16x32_bf16 v[64:67], a[88:91], a[52:55], v[64:67]
    ds_read_b64_tr_b16 a[72:73], v120 offset:32768
    v_mfma_f32_16x16x32_bf16 v[68:71], a[88:91], a[56:59], v[68:71]
    v_mfma_f32_16x16x32_bf16 v[72:75], a[88:91], a[60:63], v[72:75]
    ds_read_b64_tr_b16 a[74:75], v120 offset:36864
    v_mfma_f32_16x16x32_bf16 v[76:79], a[92:95], a[48:51], v[76:79]
    ds_read_b64_tr_b16 a[76:77], v126 offset:32768
    v_mfma_f32_16x16x32_bf16 v[80:83], a[92:95], a[52:55], v[80:83]
    ds_read_b64_tr_b16 a[78:79], v126 offset:36864
    v_mfma_f32_16x16x32_bf16 v[84:87], a[92:95], a[56:59], v[84:87]
    v_mfma_f32_16x16x32_bf16 v[88:91], a[92:95], a[60:63], v[88:91]
    s_waitcnt lgkmcnt(4)
    v_mfma_f32_16x16x32_bf16 v[92:95], a[64:67], v[116:119], v[92:95]
    v_mfma_f32_16x16x32_bf16 v[28:31], a[64:67], a[32:35], v[28:31]
    ds_read_b64_tr_b16 a[80:81], v26 offset:49152
    v_mfma_f32_16x16x32_bf16 v[32:35], a[64:67], a[36:39], v[32:35]
    ds_read_b64_tr_b16 a[82:83], v26 offset:53248
    v_mfma_f32_16x16x32_bf16 v[36:39], a[64:67], a[40:43], v[36:39]
    ds_read_b128 a[48:51], v25 offset:32768
    v_mfma_f32_16x16x32_bf16 v[40:43], a[64:67], a[44:47], v[40:43]
    v_mfma_f32_16x16x32_bf16 v[96:99], a[68:71], v[116:119], v[96:99]
    ds_read_b128 a[52:55], v25 offset:36864
    v_mfma_f32_16x16x32_bf16 v[44:47], a[68:71], a[32:35], v[44:47]
    ds_read_b128 a[56:59], v25 offset:40960
    v_mfma_f32_16x16x32_bf16 v[48:51], a[68:71], a[36:39], v[48:51]
    ds_read_b128 a[60:63], v25 offset:45056
    v_mfma_f32_16x16x32_bf16 v[52:55], a[68:71], a[40:43], v[52:55]
    v_mfma_f32_16x16x32_bf16 v[56:59], a[68:71], a[44:47], v[56:59]
    ds_read_b64_tr_b16 a[84:85], v27 offset:49152
    s_waitcnt lgkmcnt(7)
    v_mfma_f32_16x16x32_bf16 v[60:63], a[72:75], a[32:35], v[60:63]
    ds_read_b64_tr_b16 a[86:87], v27 offset:53248
    v_mfma_f32_16x16x32_bf16 v[64:67], a[72:75], a[36:39], v[64:67]
    ds_read_b64_tr_b16 a[88:89], v120 offset:49152
    v_mfma_f32_16x16x32_bf16 v[68:71], a[72:75], a[40:43], v[68:71]
    v_mfma_f32_16x16x32_bf16 v[72:75], a[72:75], a[44:47], v[72:75]
    ds_read_b64_tr_b16 a[90:91], v120 offset:53248
    v_mfma_f32_16x16x32_bf16 v[76:79], a[76:79], a[32:35], v[76:79]
    ds_read_b64_tr_b16 a[92:93], v126 offset:49152
    v_mfma_f32_16x16x32_bf16 v[80:83], a[76:79], a[36:39], v[80:83]
    ds_read_b64_tr_b16 a[94:95], v126 offset:53248
    v_mfma_f32_16x16x32_bf16 v[84:87], a[76:79], a[40:43], v[84:87]
    v_mfma_f32_16x16x32_bf16 v[88:91], a[76:79], a[44:47], v[88:91]
    s_barrier
    s_waitcnt lgkmcnt(4)
    v_mfma_f32_16x16x32_bf16 v[92:95], a[80:83], v[116:119], v[92:95]
    v_add_u32 v24, 0x10000, v24
    v_mfma_f32_16x16x32_bf16 v[28:31], a[80:83], a[48:51], v[28:31]
    v_add_u32 v25, 0x10000, v25
    v_mfma_f32_16x16x32_bf16 v[32:35], a[80:83], a[52:55], v[32:35]
    v_add_u32 v26, 0x10000, v26
    v_mfma_f32_16x16x32_bf16 v[36:39], a[80:83], a[56:59], v[36:39]
    v_add_u32 v27, 0x10000, v27
    v_mfma_f32_16x16x32_bf16 v[40:43], a[80:83], a[60:63], v[40:43]
    v_add_u32 v120, 0x10000, v120
    v_mfma_f32_16x16x32_bf16 v[96:99], a[84:87], v[116:119], v[96:99]
    v_add_u32 v126, 0x10000, v126
    v_mfma_f32_16x16x32_bf16 v[44:47], a[84:87], a[48:51], v[44:47]
    ds_read_b64_tr_b16 a[64:65], v26 offset:0
    v_mfma_f32_16x16x32_bf16 v[48:51], a[84:87], a[52:55], v[48:51]
    ds_read_b64_tr_b16 a[66:67], v26 offset:4096
    ds_read_b128 a[32:35], v24 offset:0
    v_mfma_f32_16x16x32_bf16 v[52:55], a[84:87], a[56:59], v[52:55]
    ds_read_b128 a[36:39], v24 offset:4096
    v_mfma_f32_16x16x32_bf16 v[56:59], a[84:87], a[60:63], v[56:59]
    ds_read_b128 a[40:43], v24 offset:8192
    s_waitcnt lgkmcnt(5)
    v_mfma_f32_16x16x32_bf16 v[60:63], a[88:91], a[48:51], v[60:63]
    ds_read_b128 a[44:47], v24 offset:12288
    v_mfma_f32_16x16x32_bf16 v[64:67], a[88:91], a[52:55], v[64:67]
    ds_read_b64_tr_b16 a[68:69], v27 offset:0
    v_mfma_f32_16x16x32_bf16 v[68:71], a[88:91], a[56:59], v[68:71]
    ds_read_b64_tr_b16 a[70:71], v27 offset:4096
    v_mfma_f32_16x16x32_bf16 v[72:75], a[88:91], a[60:63], v[72:75]
    ds_read_b64_tr_b16 a[72:73], v120 offset:0
    v_mfma_f32_16x16x32_bf16 v[76:79], a[92:95], a[48:51], v[76:79]
    ds_read_b64_tr_b16 a[74:75], v120 offset:4096
    v_mfma_f32_16x16x32_bf16 v[80:83], a[92:95], a[52:55], v[80:83]
    ds_read_b64_tr_b16 a[76:77], v126 offset:0
    ds_read_b64_tr_b16 a[78:79], v126 offset:4096
    v_mfma_f32_16x16x32_bf16 v[84:87], a[92:95], a[56:59], v[84:87]
    v_mfma_f32_16x16x32_bf16 v[88:91], a[92:95], a[60:63], v[88:91]
    s_waitcnt lgkmcnt(4)
    v_mfma_f32_16x16x32_bf16 v[92:95], a[64:67], v[116:119], v[92:95]
    v_mfma_f32_16x16x32_bf16 v[28:31], a[64:67], a[32:35], v[28:31]
    ds_read_b64_tr_b16 a[80:81], v26 offset:16384
    v_mfma_f32_16x16x32_bf16 v[32:35], a[64:67], a[36:39], v[32:35]
    ds_read_b64_tr_b16 a[82:83], v26 offset:20480
    v_mfma_f32_16x16x32_bf16 v[36:39], a[64:67], a[40:43], v[36:39]
    ds_read_b128 a[48:51], v25 offset:0
    v_mfma_f32_16x16x32_bf16 v[40:43], a[64:67], a[44:47], v[40:43]
    v_mfma_f32_16x16x32_bf16 v[96:99], a[68:71], v[116:119], v[96:99]
    ds_read_b128 a[52:55], v25 offset:4096
    v_mfma_f32_16x16x32_bf16 v[44:47], a[68:71], a[32:35], v[44:47]
    ds_read_b128 a[56:59], v25 offset:8192
    v_mfma_f32_16x16x32_bf16 v[48:51], a[68:71], a[36:39], v[48:51]
    ds_read_b128 a[60:63], v25 offset:12288
    v_mfma_f32_16x16x32_bf16 v[52:55], a[68:71], a[40:43], v[52:55]
    v_mfma_f32_16x16x32_bf16 v[56:59], a[68:71], a[44:47], v[56:59]
    ds_read_b64_tr_b16 a[84:85], v27 offset:16384
    s_waitcnt lgkmcnt(7)
    v_mfma_f32_16x16x32_bf16 v[60:63], a[72:75], a[32:35], v[60:63]
    ds_read_b64_tr_b16 a[86:87], v27 offset:20480
    v_mfma_f32_16x16x32_bf16 v[64:67], a[72:75], a[36:39], v[64:67]
    ds_read_b64_tr_b16 a[88:89], v120 offset:16384
    v_mfma_f32_16x16x32_bf16 v[68:71], a[72:75], a[40:43], v[68:71]
    v_mfma_f32_16x16x32_bf16 v[72:75], a[72:75], a[44:47], v[72:75]
    ds_read_b64_tr_b16 a[90:91], v120 offset:20480
    v_mfma_f32_16x16x32_bf16 v[76:79], a[76:79], a[32:35], v[76:79]
    ds_read_b64_tr_b16 a[92:93], v126 offset:16384
    v_mfma_f32_16x16x32_bf16 v[80:83], a[76:79], a[36:39], v[80:83]
    ds_read_b64_tr_b16 a[94:95], v126 offset:20480
    v_mfma_f32_16x16x32_bf16 v[84:87], a[76:79], a[40:43], v[84:87]
    v_mfma_f32_16x16x32_bf16 v[88:91], a[76:79], a[44:47], v[88:91]
    s_barrier
    s_waitcnt lgkmcnt(4)
    v_mfma_f32_16x16x32_bf16 v[92:95], a[80:83], v[116:119], v[92:95]
    v_add_u32 v24, 0xfffe0000, v24
    v_mfma_f32_16x16x32_bf16 v[28:31], a[80:83], a[48:51], v[28:31]
    v_add_u32 v25, 0xfffe0000, v25
    v_mfma_f32_16x16x32_bf16 v[32:35], a[80:83], a[52:55], v[32:35]
    v_add_u32 v26, 0xfffe0000, v26
    v_mfma_f32_16x16x32_bf16 v[36:39], a[80:83], a[56:59], v[36:39]
    v_add_u32 v27, 0xfffe0000, v27
    v_mfma_f32_16x16x32_bf16 v[40:43], a[80:83], a[60:63], v[40:43]
    v_add_u32 v120, 0xfffe0000, v120
    v_mfma_f32_16x16x32_bf16 v[96:99], a[84:87], v[116:119], v[96:99]
    v_add_u32 v126, 0xfffe0000, v126
    v_mfma_f32_16x16x32_bf16 v[44:47], a[84:87], a[48:51], v[44:47]
    ds_read_b64_tr_b16 a[64:65], v26 offset:0
    v_mfma_f32_16x16x32_bf16 v[48:51], a[84:87], a[52:55], v[48:51]
    ds_read_b64_tr_b16 a[66:67], v26 offset:4096
    ds_read_b128 a[32:35], v24 offset:0
    v_mfma_f32_16x16x32_bf16 v[52:55], a[84:87], a[56:59], v[52:55]
    ds_read_b128 a[36:39], v24 offset:4096
    v_mfma_f32_16x16x32_bf16 v[56:59], a[84:87], a[60:63], v[56:59]
    ds_read_b128 a[40:43], v24 offset:8192
    s_waitcnt lgkmcnt(5)
    v_mfma_f32_16x16x32_bf16 v[60:63], a[88:91], a[48:51], v[60:63]
    ds_read_b128 a[44:47], v24 offset:12288
    v_mfma_f32_16x16x32_bf16 v[64:67], a[88:91], a[52:55], v[64:67]
    ds_read_b64_tr_b16 a[68:69], v27 offset:0
    v_mfma_f32_16x16x32_bf16 v[68:71], a[88:91], a[56:59], v[68:71]
    ds_read_b64_tr_b16 a[70:71], v27 offset:4096
    v_mfma_f32_16x16x32_bf16 v[72:75], a[88:91], a[60:63], v[72:75]
    ds_read_b64_tr_b16 a[72:73], v120 offset:0
    v_mfma_f32_16x16x32_bf16 v[76:79], a[92:95], a[48:51], v[76:79]
    ds_read_b64_tr_b16 a[74:75], v120 offset:4096
    v_mfma_f32_16x16x32_bf16 v[80:83], a[92:95], a[52:55], v[80:83]
    ds_read_b64_tr_b16 a[76:77], v126 offset:0
    ds_read_b64_tr_b16 a[78:79], v126 offset:4096
    v_mfma_f32_16x16x32_bf16 v[84:87], a[92:95], a[56:59], v[84:87]
    v_mfma_f32_16x16x32_bf16 v[88:91], a[92:95], a[60:63], v[88:91]
    s_waitcnt lgkmcnt(4)
    v_mfma_f32_16x16x32_bf16 v[92:95], a[64:67], v[116:119], v[92:95]
    ds_read_b64_tr_b16 a[80:81], v26 offset:16384
    v_mfma_f32_16x16x32_bf16 v[28:31], a[64:67], a[32:35], v[28:31]
    ds_read_b64_tr_b16 a[82:83], v26 offset:20480
    v_mfma_f32_16x16x32_bf16 v[32:35], a[64:67], a[36:39], v[32:35]
    ds_read_b128 a[48:51], v25 offset:0
    v_mfma_f32_16x16x32_bf16 v[36:39], a[64:67], a[40:43], v[36:39]
    ds_read_b128 a[52:55], v25 offset:4096
    v_mfma_f32_16x16x32_bf16 v[40:43], a[64:67], a[44:47], v[40:43]
    ds_read_b128 a[56:59], v25 offset:8192
    v_mfma_f32_16x16x32_bf16 v[96:99], a[68:71], v[116:119], v[96:99]
    ds_read_b128 a[60:63], v25 offset:12288
    v_mfma_f32_16x16x32_bf16 v[44:47], a[68:71], a[32:35], v[44:47]
    ds_read_b64_tr_b16 a[84:85], v27 offset:16384
    v_mfma_f32_16x16x32_bf16 v[48:51], a[68:71], a[36:39], v[48:51]
    ds_read_b64_tr_b16 a[86:87], v27 offset:20480
    v_mfma_f32_16x16x32_bf16 v[52:55], a[68:71], a[40:43], v[52:55]
    ds_read_b64_tr_b16 a[88:89], v120 offset:16384
    v_mfma_f32_16x16x32_bf16 v[56:59], a[68:71], a[44:47], v[56:59]
    ds_read_b64_tr_b16 a[90:91], v120 offset:20480
    s_waitcnt lgkmcnt(10)
    v_mfma_f32_16x16x32_bf16 v[60:63], a[72:75], a[32:35], v[60:63]
    ds_read_b64_tr_b16 a[92:93], v126 offset:16384
    v_mfma_f32_16x16x32_bf16 v[64:67], a[72:75], a[36:39], v[64:67]
    ds_read_b64_tr_b16 a[94:95], v126 offset:20480
    v_mfma_f32_16x16x32_bf16 v[68:71], a[72:75], a[40:43], v[68:71]
    buffer_load_dwordx2 v[128:129], v121, s[44:47], 0 offen offset:0 sc1
    buffer_load_dwordx2 v[130:131], v121, s[44:47], 0 offen offset:128 sc1
    buffer_load_dwordx2 v[132:133], v121, s[44:47], 0 offen offset:256 sc1
    buffer_load_dwordx2 v[134:135], v121, s[44:47], 0 offen offset:384 sc1
    v_mfma_f32_16x16x32_bf16 v[72:75], a[72:75], a[44:47], v[72:75]
    buffer_store_dwordx4 v[100:103], v2, s[44:47], s9 offen offset:0 sc1
    v_mfma_f32_16x16x32_bf16 v[76:79], a[76:79], a[32:35], v[76:79]
    buffer_store_dwordx4 v[104:107], v2, s[44:47], s10 offen offset:0 sc1
    v_mfma_f32_16x16x32_bf16 v[80:83], a[76:79], a[36:39], v[80:83]
    buffer_store_dwordx4 v[108:111], v2, s[44:47], s9 offen offset:1024 sc1
    buffer_store_dwordx4 v[112:115], v2, s[44:47], s10 offen offset:1024 sc1
    v_mfma_f32_16x16x32_bf16 v[84:87], a[76:79], a[40:43], v[84:87]
    v_mfma_f32_16x16x32_bf16 v[88:91], a[76:79], a[44:47], v[88:91]
    s_barrier
    s_waitcnt lgkmcnt(4)
    v_mfma_f32_16x16x32_bf16 v[92:95], a[80:83], v[116:119], v[92:95]
    v_mfma_f32_16x16x32_bf16 v[28:31], a[80:83], a[48:51], v[28:31]
    ds_read_b64_tr_b16 a[64:65], v26 offset:32768
    v_mfma_f32_16x16x32_bf16 v[32:35], a[80:83], a[52:55], v[32:35]
    ds_read_b64_tr_b16 a[66:67], v26 offset:36864
    v_mfma_f32_16x16x32_bf16 v[36:39], a[80:83], a[56:59], v[36:39]
    ds_read_b128 a[32:35], v24 offset:32768
    v_mfma_f32_16x16x32_bf16 v[40:43], a[80:83], a[60:63], v[40:43]
    v_mfma_f32_16x16x32_bf16 v[96:99], a[84:87], v[116:119], v[96:99]
    ds_read_b128 a[36:39], v24 offset:36864
    v_mfma_f32_16x16x32_bf16 v[44:47], a[84:87], a[48:51], v[44:47]
    ds_read_b128 a[40:43], v24 offset:40960
    v_mfma_f32_16x16x32_bf16 v[48:51], a[84:87], a[52:55], v[48:51]
    ds_read_b128 a[44:47], v24 offset:45056
    v_mfma_f32_16x16x32_bf16 v[52:55], a[84:87], a[56:59], v[52:55]
    v_mfma_f32_16x16x32_bf16 v[56:59], a[84:87], a[60:63], v[56:59]
    ds_read_b64_tr_b16 a[68:69], v27 offset:32768
    s_waitcnt lgkmcnt(7)
    v_mfma_f32_16x16x32_bf16 v[60:63], a[88:91], a[48:51], v[60:63]
    ds_read_b64_tr_b16 a[70:71], v27 offset:36864
    v_mfma_f32_16x16x32_bf16 v[64:67], a[88:91], a[52:55], v[64:67]
    ds_read_b64_tr_b16 a[72:73], v120 offset:32768
    v_mfma_f32_16x16x32_bf16 v[68:71], a[88:91], a[56:59], v[68:71]
    v_mfma_f32_16x16x32_bf16 v[72:75], a[88:91], a[60:63], v[72:75]
    ds_read_b64_tr_b16 a[74:75], v120 offset:36864
    v_mfma_f32_16x16x32_bf16 v[76:79], a[92:95], a[48:51], v[76:79]
    ds_read_b64_tr_b16 a[76:77], v126 offset:32768
    v_mfma_f32_16x16x32_bf16 v[80:83], a[92:95], a[52:55], v[80:83]
    ds_read_b64_tr_b16 a[78:79], v126 offset:36864
    v_mfma_f32_16x16x32_bf16 v[84:87], a[92:95], a[56:59], v[84:87]
    v_mfma_f32_16x16x32_bf16 v[88:91], a[92:95], a[60:63], v[88:91]
    s_waitcnt lgkmcnt(4)
    v_mfma_f32_16x16x32_bf16 v[92:95], a[64:67], v[116:119], v[92:95]
    v_mfma_f32_16x16x32_bf16 v[28:31], a[64:67], a[32:35], v[28:31]
    ds_read_b64_tr_b16 a[80:81], v26 offset:49152
    v_mfma_f32_16x16x32_bf16 v[32:35], a[64:67], a[36:39], v[32:35]
    ds_read_b64_tr_b16 a[82:83], v26 offset:53248
    v_mfma_f32_16x16x32_bf16 v[36:39], a[64:67], a[40:43], v[36:39]
    ds_read_b128 a[48:51], v25 offset:32768
    v_mfma_f32_16x16x32_bf16 v[40:43], a[64:67], a[44:47], v[40:43]
    v_mfma_f32_16x16x32_bf16 v[96:99], a[68:71], v[116:119], v[96:99]
    ds_read_b128 a[52:55], v25 offset:36864
    v_mfma_f32_16x16x32_bf16 v[44:47], a[68:71], a[32:35], v[44:47]
    ds_read_b128 a[56:59], v25 offset:40960
    v_mfma_f32_16x16x32_bf16 v[48:51], a[68:71], a[36:39], v[48:51]
    ds_read_b128 a[60:63], v25 offset:45056
    v_mfma_f32_16x16x32_bf16 v[52:55], a[68:71], a[40:43], v[52:55]
    v_mfma_f32_16x16x32_bf16 v[56:59], a[68:71], a[44:47], v[56:59]
    ds_read_b64_tr_b16 a[84:85], v27 offset:49152
    s_waitcnt lgkmcnt(7)
    v_mfma_f32_16x16x32_bf16 v[60:63], a[72:75], a[32:35], v[60:63]
    ds_read_b64_tr_b16 a[86:87], v27 offset:53248
    v_mfma_f32_16x16x32_bf16 v[64:67], a[72:75], a[36:39], v[64:67]
    ds_read_b64_tr_b16 a[88:89], v120 offset:49152
    v_mfma_f32_16x16x32_bf16 v[68:71], a[72:75], a[40:43], v[68:71]
    v_mfma_f32_16x16x32_bf16 v[72:75], a[72:75], a[44:47], v[72:75]
    ds_read_b64_tr_b16 a[90:91], v120 offset:53248
    v_mfma_f32_16x16x32_bf16 v[76:79], a[76:79], a[32:35], v[76:79]
    ds_read_b64_tr_b16 a[92:93], v126 offset:49152
    v_mfma_f32_16x16x32_bf16 v[80:83], a[76:79], a[36:39], v[80:83]
    ds_read_b64_tr_b16 a[94:95], v126 offset:53248
    v_mfma_f32_16x16x32_bf16 v[84:87], a[76:79], a[40:43], v[84:87]
    v_mfma_f32_16x16x32_bf16 v[88:91], a[76:79], a[44:47], v[88:91]
    s_barrier
    s_waitcnt lgkmcnt(4)
    v_mfma_f32_16x16x32_bf16 v[92:95], a[80:83], v[116:119], v[92:95]
    v_add_u32 v24, 0x10000, v24
    v_mfma_f32_16x16x32_bf16 v[28:31], a[80:83], a[48:51], v[28:31]
    v_add_u32 v25, 0x10000, v25
    v_mfma_f32_16x16x32_bf16 v[32:35], a[80:83], a[52:55], v[32:35]
    v_add_u32 v26, 0x10000, v26
    v_mfma_f32_16x16x32_bf16 v[36:39], a[80:83], a[56:59], v[36:39]
    v_add_u32 v27, 0x10000, v27
    v_mfma_f32_16x16x32_bf16 v[40:43], a[80:83], a[60:63], v[40:43]
    v_add_u32 v120, 0x10000, v120
    v_mfma_f32_16x16x32_bf16 v[96:99], a[84:87], v[116:119], v[96:99]
    v_add_u32 v126, 0x10000, v126
    v_mfma_f32_16x16x32_bf16 v[44:47], a[84:87], a[48:51], v[44:47]
    ds_read_b64_tr_b16 a[64:65], v26 offset:0
    v_mfma_f32_16x16x32_bf16 v[48:51], a[84:87], a[52:55], v[48:51]
    ds_read_b64_tr_b16 a[66:67], v26 offset:4096
    ds_read_b128 a[32:35], v24 offset:0
    v_mfma_f32_16x16x32_bf16 v[52:55], a[84:87], a[56:59], v[52:55]
    ds_read_b128 a[36:39], v24 offset:4096
    v_mfma_f32_16x16x32_bf16 v[56:59], a[84:87], a[60:63], v[56:59]
    ds_read_b128 a[40:43], v24 offset:8192
    s_waitcnt lgkmcnt(5)
    v_mfma_f32_16x16x32_bf16 v[60:63], a[88:91], a[48:51], v[60:63]
    ds_read_b128 a[44:47], v24 offset:12288
    v_mfma_f32_16x16x32_bf16 v[64:67], a[88:91], a[52:55], v[64:67]
    ds_read_b64_tr_b16 a[68:69], v27 offset:0
    v_mfma_f32_16x16x32_bf16 v[68:71], a[88:91], a[56:59], v[68:71]
    ds_read_b64_tr_b16 a[70:71], v27 offset:4096
    v_mfma_f32_16x16x32_bf16 v[72:75], a[88:91], a[60:63], v[72:75]
    ds_read_b64_tr_b16 a[72:73], v120 offset:0
    v_mfma_f32_16x16x32_bf16 v[76:79], a[92:95], a[48:51], v[76:79]
    ds_read_b64_tr_b16 a[74:75], v120 offset:4096
    v_mfma_f32_16x16x32_bf16 v[80:83], a[92:95], a[52:55], v[80:83]
    ds_read_b64_tr_b16 a[76:77], v126 offset:0
    ds_read_b64_tr_b16 a[78:79], v126 offset:4096
    v_mfma_f32_16x16x32_bf16 v[84:87], a[92:95], a[56:59], v[84:87]
    v_mfma_f32_16x16x32_bf16 v[88:91], a[92:95], a[60:63], v[88:91]
    s_waitcnt lgkmcnt(4)
    v_mfma_f32_16x16x32_bf16 v[92:95], a[64:67], v[116:119], v[92:95]
    v_mfma_f32_16x16x32_bf16 v[28:31], a[64:67], a[32:35], v[28:31]
    ds_read_b64_tr_b16 a[80:81], v26 offset:16384
    v_mfma_f32_16x16x32_bf16 v[32:35], a[64:67], a[36:39], v[32:35]
    ds_read_b64_tr_b16 a[82:83], v26 offset:20480
    v_mfma_f32_16x16x32_bf16 v[36:39], a[64:67], a[40:43], v[36:39]
    ds_read_b128 a[48:51], v25 offset:0
    v_mfma_f32_16x16x32_bf16 v[40:43], a[64:67], a[44:47], v[40:43]
    v_mfma_f32_16x16x32_bf16 v[96:99], a[68:71], v[116:119], v[96:99]
    ds_read_b128 a[52:55], v25 offset:4096
    v_mfma_f32_16x16x32_bf16 v[44:47], a[68:71], a[32:35], v[44:47]
    ds_read_b128 a[56:59], v25 offset:8192
    v_mfma_f32_16x16x32_bf16 v[48:51], a[68:71], a[36:39], v[48:51]
    ds_read_b128 a[60:63], v25 offset:12288
    v_mfma_f32_16x16x32_bf16 v[52:55], a[68:71], a[40:43], v[52:55]
    v_mfma_f32_16x16x32_bf16 v[56:59], a[68:71], a[44:47], v[56:59]
    ds_read_b64_tr_b16 a[84:85], v27 offset:16384
    s_waitcnt lgkmcnt(7)
    v_mfma_f32_16x16x32_bf16 v[60:63], a[72:75], a[32:35], v[60:63]
    ds_read_b64_tr_b16 a[86:87], v27 offset:20480
    v_mfma_f32_16x16x32_bf16 v[64:67], a[72:75], a[36:39], v[64:67]
    ds_read_b64_tr_b16 a[88:89], v120 offset:16384
    v_mfma_f32_16x16x32_bf16 v[68:71], a[72:75], a[40:43], v[68:71]
    v_mfma_f32_16x16x32_bf16 v[72:75], a[72:75], a[44:47], v[72:75]
    ds_read_b64_tr_b16 a[90:91], v120 offset:20480
    v_mfma_f32_16x16x32_bf16 v[76:79], a[76:79], a[32:35], v[76:79]
    ds_read_b64_tr_b16 a[92:93], v126 offset:16384
    v_mfma_f32_16x16x32_bf16 v[80:83], a[76:79], a[36:39], v[80:83]
    ds_read_b64_tr_b16 a[94:95], v126 offset:20480
    v_mfma_f32_16x16x32_bf16 v[84:87], a[76:79], a[40:43], v[84:87]
    v_mfma_f32_16x16x32_bf16 v[88:91], a[76:79], a[44:47], v[88:91]
    s_barrier
    s_waitcnt lgkmcnt(4)
    v_mfma_f32_16x16x32_bf16 v[92:95], a[80:83], v[116:119], v[92:95]
    v_mfma_f32_16x16x32_bf16 v[28:31], a[80:83], a[48:51], v[28:31]
    ds_read_b64_tr_b16 a[64:65], v26 offset:32768
    v_mfma_f32_16x16x32_bf16 v[32:35], a[80:83], a[52:55], v[32:35]
    ds_read_b64_tr_b16 a[66:67], v26 offset:36864
    v_mfma_f32_16x16x32_bf16 v[36:39], a[80:83], a[56:59], v[36:39]
    ds_read_b128 a[32:35], v24 offset:32768
    v_mfma_f32_16x16x32_bf16 v[40:43], a[80:83], a[60:63], v[40:43]
    v_mfma_f32_16x16x32_bf16 v[96:99], a[84:87], v[116:119], v[96:99]
    ds_read_b128 a[36:39], v24 offset:36864
    v_mfma_f32_16x16x32_bf16 v[44:47], a[84:87], a[48:51], v[44:47]
    ds_read_b128 a[40:43], v24 offset:40960
    v_mfma_f32_16x16x32_bf16 v[48:51], a[84:87], a[52:55], v[48:51]
    ds_read_b128 a[44:47], v24 offset:45056
    v_mfma_f32_16x16x32_bf16 v[52:55], a[84:87], a[56:59], v[52:55]
    v_mfma_f32_16x16x32_bf16 v[56:59], a[84:87], a[60:63], v[56:59]
    ds_read_b64_tr_b16 a[68:69], v27 offset:32768
    s_waitcnt lgkmcnt(7)
    v_mfma_f32_16x16x32_bf16 v[60:63], a[88:91], a[48:51], v[60:63]
    ds_read_b64_tr_b16 a[70:71], v27 offset:36864
    v_mfma_f32_16x16x32_bf16 v[64:67], a[88:91], a[52:55], v[64:67]
    ds_read_b64_tr_b16 a[72:73], v120 offset:32768
    v_mfma_f32_16x16x32_bf16 v[68:71], a[88:91], a[56:59], v[68:71]
    v_mfma_f32_16x16x32_bf16 v[72:75], a[88:91], a[60:63], v[72:75]
    ds_read_b64_tr_b16 a[74:75], v120 offset:36864
    v_mfma_f32_16x16x32_bf16 v[76:79], a[92:95], a[48:51], v[76:79]
    ds_read_b64_tr_b16 a[76:77], v126 offset:32768
    v_mfma_f32_16x16x32_bf16 v[80:83], a[92:95], a[52:55], v[80:83]
    ds_read_b64_tr_b16 a[78:79], v126 offset:36864
    v_mfma_f32_16x16x32_bf16 v[84:87], a[92:95], a[56:59], v[84:87]
    v_mfma_f32_16x16x32_bf16 v[88:91], a[92:95], a[60:63], v[88:91]
    s_waitcnt lgkmcnt(4)
    v_mfma_f32_16x16x32_bf16 v[92:95], a[64:67], v[116:119], v[92:95]
    v_mfma_f32_16x16x32_bf16 v[28:31], a[64:67], a[32:35], v[28:31]
    ds_read_b64_tr_b16 a[80:81], v26 offset:49152
    v_mfma_f32_16x16x32_bf16 v[32:35], a[64:67], a[36:39], v[32:35]
    ds_read_b64_tr_b16 a[82:83], v26 offset:53248
    v_mfma_f32_16x16x32_bf16 v[36:39], a[64:67], a[40:43], v[36:39]
    ds_read_b128 a[48:51], v25 offset:32768
    v_mfma_f32_16x16x32_bf16 v[40:43], a[64:67], a[44:47], v[40:43]
    v_mfma_f32_16x16x32_bf16 v[96:99], a[68:71], v[116:119], v[96:99]
    ds_read_b128 a[52:55], v25 offset:36864
    v_mfma_f32_16x16x32_bf16 v[44:47], a[68:71], a[32:35], v[44:47]
    ds_read_b128 a[56:59], v25 offset:40960
    v_mfma_f32_16x16x32_bf16 v[48:51], a[68:71], a[36:39], v[48:51]
    ds_read_b128 a[60:63], v25 offset:45056
    v_mfma_f32_16x16x32_bf16 v[52:55], a[68:71], a[40:43], v[52:55]
    v_mfma_f32_16x16x32_bf16 v[56:59], a[68:71], a[44:47], v[56:59]
    ds_read_b64_tr_b16 a[84:85], v27 offset:49152
    s_waitcnt lgkmcnt(7)
    v_mfma_f32_16x16x32_bf16 v[60:63], a[72:75], a[32:35], v[60:63]
    ds_read_b64_tr_b16 a[86:87], v27 offset:53248
    v_mfma_f32_16x16x32_bf16 v[64:67], a[72:75], a[36:39], v[64:67]
    ds_read_b64_tr_b16 a[88:89], v120 offset:49152
    v_mfma_f32_16x16x32_bf16 v[68:71], a[72:75], a[40:43], v[68:71]
    v_mfma_f32_16x16x32_bf16 v[72:75], a[72:75], a[44:47], v[72:75]
    ds_read_b64_tr_b16 a[90:91], v120 offset:53248
    v_mfma_f32_16x16x32_bf16 v[76:79], a[76:79], a[32:35], v[76:79]
    ds_read_b64_tr_b16 a[92:93], v126 offset:49152
    v_mfma_f32_16x16x32_bf16 v[80:83], a[76:79], a[36:39], v[80:83]
    ds_read_b64_tr_b16 a[94:95], v126 offset:53248
    v_mfma_f32_16x16x32_bf16 v[84:87], a[76:79], a[40:43], v[84:87]
    v_mfma_f32_16x16x32_bf16 v[88:91], a[76:79], a[44:47], v[88:91]
    s_waitcnt lgkmcnt(4)
    v_mfma_f32_16x16x32_bf16 v[92:95], a[80:83], v[116:119], v[92:95]
    v_mfma_f32_16x16x32_bf16 v[28:31], a[80:83], a[48:51], v[28:31]
    v_mfma_f32_16x16x32_bf16 v[32:35], a[80:83], a[52:55], v[32:35]
    v_mfma_f32_16x16x32_bf16 v[36:39], a[80:83], a[56:59], v[36:39]
    v_mfma_f32_16x16x32_bf16 v[40:43], a[80:83], a[60:63], v[40:43]
    v_mfma_f32_16x16x32_bf16 v[96:99], a[84:87], v[116:119], v[96:99]
    v_mfma_f32_16x16x32_bf16 v[44:47], a[84:87], a[48:51], v[44:47]
    v_mfma_f32_16x16x32_bf16 v[48:51], a[84:87], a[52:55], v[48:51]
    v_mfma_f32_16x16x32_bf16 v[52:55], a[84:87], a[56:59], v[52:55]
    v_mfma_f32_16x16x32_bf16 v[56:59], a[84:87], a[60:63], v[56:59]
    s_waitcnt lgkmcnt(0)
    v_mfma_f32_16x16x32_bf16 v[60:63], a[88:91], a[48:51], v[60:63]
    v_mfma_f32_16x16x32_bf16 v[64:67], a[88:91], a[52:55], v[64:67]
    v_mfma_f32_16x16x32_bf16 v[68:71], a[88:91], a[56:59], v[68:71]
    v_mfma_f32_16x16x32_bf16 v[72:75], a[88:91], a[60:63], v[72:75]
    v_mfma_f32_16x16x32_bf16 v[76:79], a[92:95], a[48:51], v[76:79]
    v_mfma_f32_16x16x32_bf16 v[80:83], a[92:95], a[52:55], v[80:83]
    s_mov_b32 s62, 0x00010001
    s_mov_b32 s63, 0x00010001
    s_mov_b64 exec, s[62:63]
    ds_write_b128 v122, v[92:95]
    ds_write_b128 v122, v[96:99] offset:64
    s_mov_b64 exec, -1
    v_mfma_f32_16x16x32_bf16 v[84:87], a[92:95], a[56:59], v[84:87]
    v_mfma_f32_16x16x32_bf16 v[88:91], a[92:95], a[60:63], v[88:91]
    s_waitcnt vmcnt(4)
    s_mov_b32 s61, 0
Ltc0:
    v_xor_b32 v136, v129, v4
    v_xor_b32 v137, v131, v4
    v_or_b32 v136, v136, v137
    v_xor_b32 v137, v133, v4
    v_or_b32 v136, v136, v137
    v_xor_b32 v137, v135, v4
    v_or_b32 v136, v136, v137
    v_cmp_ne_u32 vcc, 0, v136
    s_cbranch_vccz Ltco0
    s_add_u32 s61, s61, 1
    s_cmp_gt_u32 s61, 20000
    s_cbranch_scc1 Ltco0
    buffer_load_dwordx2 v[128:129], v121, s[44:47], 0 offen offset:0 sc1
    buffer_load_dwordx2 v[130:131], v121, s[44:47], 0 offen offset:128 sc1
    buffer_load_dwordx2 v[132:133], v121, s[44:47], 0 offen offset:256 sc1
    buffer_load_dwordx2 v[134:135], v121, s[44:47], 0 offen offset:384 sc1
    s_waitcnt vmcnt(0)
    s_branch Ltc0
Ltco0:
    v_lshlrev_b32 v100, 16, v128
    v_and_b32 v102, 0xffff0000, v128
    v_rcp_f32 v101, v102
    v_lshlrev_b32 v104, 16, v130
    v_and_b32 v106, 0xffff0000, v130
    v_rcp_f32 v105, v106
    v_lshlrev_b32 v108, 16, v132
    v_and_b32 v110, 0xffff0000, v132
    v_rcp_f32 v109, v110
    v_lshlrev_b32 v112, 16, v134
    v_and_b32 v114, 0xffff0000, v134
    v_rcp_f32 v113, v114
    v_mul_f32 v128, 0xbfb8aa3b, v101
    v_mul_f32 v130, 0xbfb8aa3b, v105
    v_mul_f32 v132, 0xbfb8aa3b, v109
    v_mul_f32 v134, 0xbfb8aa3b, v113
    s_waitcnt lgkmcnt(0)
    s_barrier
    s_cmp_eq_u32 s59, 7
    s_cbranch_scc1 Lnoepi
    ds_read_b128 v[116:119], v125
    ds_read_b128 v[120:123], v125 offset:64
    v_pk_fma_f32 v[28:29], v[92:93], v[100:101], v[28:29] op_sel_hi:[1,0,1]
    v_pk_fma_f32 v[30:31], v[94:95], v[100:101], v[30:31] op_sel_hi:[1,0,1]
    v_pk_mul_f32 v[136:137], v[28:29], v[128:129] op_sel_hi:[1,0]
    v_pk_mul_f32 v[138:139], v[30:31], v[128:129] op_sel_hi:[1,0]
    v_exp_f32 v136, v136
    v_exp_f32 v137, v137
    v_exp_f32 v138, v138
    v_exp_f32 v139, v139
    v_pk_fma_f32 v[136:137], v[136:137], v[102:103], v[102:103] op_sel_hi:[1,0,0]
    v_pk_fma_f32 v[138:139], v[138:139], v[102:103], v[102:103] op_sel_hi:[1,0,0]
    v_rcp_f32 v136, v136
    v_rcp_f32 v137, v137
    v_rcp_f32 v138, v138
    v_rcp_f32 v139, v139
    v_pk_mul_f32 v[28:29], v[28:29], v[136:137]
    v_pk_mul_f32 v[30:31], v[30:31], v[138:139]
    v_cvt_pk_bf16_f32 v28, v28, v29
    v_cvt_pk_bf16_f32 v29, v30, v31
    v_pk_fma_f32 v[44:45], v[96:97], v[100:101], v[44:45] op_sel_hi:[1,0,1]
    v_pk_fma_f32 v[46:47], v[98:99], v[100:101], v[46:47] op_sel_hi:[1,0,1]
    v_pk_mul_f32 v[140:141], v[44:45], v[128:129] op_sel_hi:[1,0]
    v_pk_mul_f32 v[142:143], v[46:47], v[128:129] op_sel_hi:[1,0]
    v_exp_f32 v140, v140
    v_exp_f32 v141, v141
    v_exp_f32 v142, v142
    v_exp_f32 v143, v143
    v_pk_fma_f32 v[140:141], v[140:141], v[102:103], v[102:103] op_sel_hi:[1,0,0]
    v_pk_fma_f32 v[142:143], v[142:143], v[102:103], v[102:103] op_sel_hi:[1,0,0]
    v_rcp_f32 v140, v140
    v_rcp_f32 v141, v141
    v_rcp_f32 v142, v142
    v_rcp_f32 v143, v143
    v_pk_mul_f32 v[44:45], v[44:45], v[140:141]
    v_pk_mul_f32 v[46:47], v[46:47], v[142:143]
    v_cvt_pk_bf16_f32 v30, v44, v45
    v_cvt_pk_bf16_f32 v31, v46, v47
    buffer_store_dwordx4 v[28:31], v2, s[44:47], s11 offen sc1
    v_pk_fma_f32 v[32:33], v[92:93], v[104:105], v[32:33] op_sel_hi:[1,0,1]
    v_pk_fma_f32 v[34:35], v[94:95], v[104:105], v[34:35] op_sel_hi:[1,0,1]
    v_pk_mul_f32 v[136:137], v[32:33], v[130:131] op_sel_hi:[1,0]
    v_pk_mul_f32 v[138:139], v[34:35], v[130:131] op_sel_hi:[1,0]
    v_exp_f32 v136, v136
    v_exp_f32 v137, v137
    v_exp_f32 v138, v138
    v_exp_f32 v139, v139
    v_pk_fma_f32 v[136:137], v[136:137], v[106:107], v[106:107] op_sel_hi:[1,0,0]
    v_pk_fma_f32 v[138:139], v[138:139], v[106:107], v[106:107] op_sel_hi:[1,0,0]
    v_rcp_f32 v136, v136
    v_rcp_f32 v137, v137
    v_rcp_f32 v138, v138
    v_rcp_f32 v139, v139
    v_pk_mul_f32 v[32:33], v[32:33], v[136:137]
    v_pk_mul_f32 v[34:35], v[34:35], v[138:139]
    v_cvt_pk_bf16_f32 v32, v32, v33
    v_cvt_pk_bf16_f32 v33, v34, v35
    v_pk_fma_f32 v[48:49], v[96:97], v[104:105], v[48:49] op_sel_hi:[1,0,1]
    v_pk_fma_f32 v[50:51], v[98:99], v[104:105], v[50:51] op_sel_hi:[1,0,1]
    v_pk_mul_f32 v[140:141], v[48:49], v[130:131] op_sel_hi:[1,0]
    v_pk_mul_f32 v[142:143], v[50:51], v[130:131] op_sel_hi:[1,0]
    v_exp_f32 v140, v140
    v_exp_f32 v141, v141
    v_exp_f32 v142, v142
    v_exp_f32 v143, v143
    v_pk_fma_f32 v[140:141], v[140:141], v[106:107], v[106:107] op_sel_hi:[1,0,0]
    v_pk_fma_f32 v[142:143], v[142:143], v[106:107], v[106:107] op_sel_hi:[1,0,0]
    v_rcp_f32 v140, v140
    v_rcp_f32 v141, v141
    v_rcp_f32 v142, v142
    v_rcp_f32 v143, v143
    v_pk_mul_f32 v[48:49], v[48:49], v[140:141]
    v_pk_mul_f32 v[50:51], v[50:51], v[142:143]
    v_cvt_pk_bf16_f32 v34, v48, v49
    v_cvt_pk_bf16_f32 v35, v50, v51
    buffer_store_dwordx4 v[32:35], v13, s[44:47], s11 offen sc1
    v_pk_fma_f32 v[36:37], v[92:93], v[108:109], v[36:37] op_sel_hi:[1,0,1]
    v_pk_fma_f32 v[38:39], v[94:95], v[108:109], v[38:39] op_sel_hi:[1,0,1]
    v_pk_mul_f32 v[136:137], v[36:37], v[132:133] op_sel_hi:[1,0]
    v_pk_mul_f32 v[138:139], v[38:39], v[132:133] op_sel_hi:[1,0]
    v_exp_f32 v136, v136
    v_exp_f32 v137, v137
    v_exp_f32 v138, v138
    v_exp_f32 v139, v139
    v_pk_fma_f32 v[136:137], v[136:137], v[110:111], v[110:111] op_sel_hi:[1,0,0]
    v_pk_fma_f32 v[138:139], v[138:139], v[110:111], v[110:111] op_sel_hi:[1,0,0]
    v_rcp_f32 v136, v136
    v_rcp_f32 v137, v137
    v_rcp_f32 v138, v138
    v_rcp_f32 v139, v139
    v_pk_mul_f32 v[36:37], v[36:37], v[136:137]
    v_pk_mul_f32 v[38:39], v[38:39], v[138:139]
    v_cvt_pk_bf16_f32 v36, v36, v37
    v_cvt_pk_bf16_f32 v37, v38, v39
    v_pk_fma_f32 v[52:53], v[96:97], v[108:109], v[52:53] op_sel_hi:[1,0,1]
    v_pk_fma_f32 v[54:55], v[98:99], v[108:109], v[54:55] op_sel_hi:[1,0,1]
    v_pk_mul_f32 v[140:141], v[52:53], v[132:133] op_sel_hi:[1,0]
    v_pk_mul_f32 v[142:143], v[54:55], v[132:133] op_sel_hi:[1,0]
    v_exp_f32 v140, v140
    v_exp_f32 v141, v141
    v_exp_f32 v142, v142
    v_exp_f32 v143, v143
    v_pk_fma_f32 v[140:141], v[140:141], v[110:111], v[110:111] op_sel_hi:[1,0,0]
    v_pk_fma_f32 v[142:143], v[142:143], v[110:111], v[110:111] op_sel_hi:[1,0,0]
    v_rcp_f32 v140, v140
    v_rcp_f32 v141, v141
    v_rcp_f32 v142, v142
    v_rcp_f32 v143, v143
    v_pk_mul_f32 v[52:53], v[52:53], v[140:141]
    v_pk_mul_f32 v[54:55], v[54:55], v[142:143]
    v_cvt_pk_bf16_f32 v38, v52, v53
    v_cvt_pk_bf16_f32 v39, v54, v55
    buffer_store_dwordx4 v[36:39], v14, s[44:47], s11 offen sc1
    v_pk_fma_f32 v[40:41], v[92:93], v[112:113], v[40:41] op_sel_hi:[1,0,1]
    v_pk_fma_f32 v[42:43], v[94:95], v[112:113], v[42:43] op_sel_hi:[1,0,1]
    v_pk_mul_f32 v[136:137], v[40:41], v[134:135] op_sel_hi:[1,0]
    v_pk_mul_f32 v[138:139], v[42:43], v[134:135] op_sel_hi:[1,0]
    v_exp_f32 v136, v136
    v_exp_f32 v137, v137
    v_exp_f32 v138, v138
    v_exp_f32 v139, v139
    v_pk_fma_f32 v[136:137], v[136:137], v[114:115], v[114:115] op_sel_hi:[1,0,0]
    v_pk_fma_f32 v[138:139], v[138:139], v[114:115], v[114:115] op_sel_hi:[1,0,0]
    v_rcp_f32 v136, v136
    v_rcp_f32 v137, v137
    v_rcp_f32 v138, v138
    v_rcp_f32 v139, v139
    v_pk_mul_f32 v[40:41], v[40:41], v[136:137]
    v_pk_mul_f32 v[42:43], v[42:43], v[138:139]
    v_cvt_pk_bf16_f32 v40, v40, v41
    v_cvt_pk_bf16_f32 v41, v42, v43
    v_pk_fma_f32 v[56:57], v[96:97], v[112:113], v[56:57] op_sel_hi:[1,0,1]
    v_pk_fma_f32 v[58:59], v[98:99], v[112:113], v[58:59] op_sel_hi:[1,0,1]
    v_pk_mul_f32 v[140:141], v[56:57], v[134:135] op_sel_hi:[1,0]
    v_pk_mul_f32 v[142:143], v[58:59], v[134:135] op_sel_hi:[1,0]
    v_exp_f32 v140, v140
    v_exp_f32 v141, v141
    v_exp_f32 v142, v142
    v_exp_f32 v143, v143
    v_pk_fma_f32 v[140:141], v[140:141], v[114:115], v[114:115] op_sel_hi:[1,0,0]
    v_pk_fma_f32 v[142:143], v[142:143], v[114:115], v[114:115] op_sel_hi:[1,0,0]
    v_rcp_f32 v140, v140
    v_rcp_f32 v141, v141
    v_rcp_f32 v142, v142
    v_rcp_f32 v143, v143
    v_pk_mul_f32 v[56:57], v[56:57], v[140:141]
    v_pk_mul_f32 v[58:59], v[58:59], v[142:143]
    v_cvt_pk_bf16_f32 v42, v56, v57
    v_cvt_pk_bf16_f32 v43, v58, v59
    buffer_store_dwordx4 v[40:43], v15, s[44:47], s11 offen sc1
    s_waitcnt lgkmcnt(0)
    v_pk_fma_f32 v[60:61], v[116:117], v[100:101], v[60:61] op_sel_hi:[1,0,1]
    v_pk_fma_f32 v[62:63], v[118:119], v[100:101], v[62:63] op_sel_hi:[1,0,1]
    v_pk_mul_f32 v[136:137], v[60:61], v[128:129] op_sel_hi:[1,0]
    v_pk_mul_f32 v[138:139], v[62:63], v[128:129] op_sel_hi:[1,0]
    v_exp_f32 v136, v136
    v_exp_f32 v137, v137
    v_exp_f32 v138, v138
    v_exp_f32 v139, v139
    v_pk_fma_f32 v[136:137], v[136:137], v[102:103], v[102:103] op_sel_hi:[1,0,0]
    v_pk_fma_f32 v[138:139], v[138:139], v[102:103], v[102:103] op_sel_hi:[1,0,0]
    v_rcp_f32 v136, v136
    v_rcp_f32 v137, v137
    v_rcp_f32 v138, v138
    v_rcp_f32 v139, v139
    v_pk_mul_f32 v[60:61], v[60:61], v[136:137]
    v_pk_mul_f32 v[62:63], v[62:63], v[138:139]
    v_cvt_pk_bf16_f32 v60, v60, v61
    v_cvt_pk_bf16_f32 v61, v62, v63
    v_pk_fma_f32 v[76:77], v[120:121], v[100:101], v[76:77] op_sel_hi:[1,0,1]
    v_pk_fma_f32 v[78:79], v[122:123], v[100:101], v[78:79] op_sel_hi:[1,0,1]
    v_pk_mul_f32 v[140:141], v[76:77], v[128:129] op_sel_hi:[1,0]
    v_pk_mul_f32 v[142:143], v[78:79], v[128:129] op_sel_hi:[1,0]
    v_exp_f32 v140, v140
    v_exp_f32 v141, v141
    v_exp_f32 v142, v142
    v_exp_f32 v143, v143
    v_pk_fma_f32 v[140:141], v[140:141], v[102:103], v[102:103] op_sel_hi:[1,0,0]
    v_pk_fma_f32 v[142:143], v[142:143], v[102:103], v[102:103] op_sel_hi:[1,0,0]
    v_rcp_f32 v140, v140
    v_rcp_f32 v141, v141
    v_rcp_f32 v142, v142
    v_rcp_f32 v143, v143
    v_pk_mul_f32 v[76:77], v[76:77], v[140:141]
    v_pk_mul_f32 v[78:79], v[78:79], v[142:143]
    v_cvt_pk_bf16_f32 v62, v76, v77
    v_cvt_pk_bf16_f32 v63, v78, v79
    buffer_store_dwordx4 v[60:63], v2, s[44:47], s12 offen sc1
    v_pk_fma_f32 v[64:65], v[116:117], v[104:105], v[64:65] op_sel_hi:[1,0,1]
    v_pk_fma_f32 v[66:67], v[118:119], v[104:105], v[66:67] op_sel_hi:[1,0,1]
    v_pk_mul_f32 v[136:137], v[64:65], v[130:131] op_sel_hi:[1,0]
    v_pk_mul_f32 v[138:139], v[66:67], v[130:131] op_sel_hi:[1,0]
    v_exp_f32 v136, v136
    v_exp_f32 v137, v137
    v_exp_f32 v138, v138
    v_exp_f32 v139, v139
    v_pk_fma_f32 v[136:137], v[136:137], v[106:107], v[106:107] op_sel_hi:[1,0,0]
    v_pk_fma_f32 v[138:139], v[138:139], v[106:107], v[106:107] op_sel_hi:[1,0,0]
    v_rcp_f32 v136, v136
    v_rcp_f32 v137, v137
    v_rcp_f32 v138, v138
    v_rcp_f32 v139, v139
    v_pk_mul_f32 v[64:65], v[64:65], v[136:137]
    v_pk_mul_f32 v[66:67], v[66:67], v[138:139]
    v_cvt_pk_bf16_f32 v64, v64, v65
    v_cvt_pk_bf16_f32 v65, v66, v67
    v_pk_fma_f32 v[80:81], v[120:121], v[104:105], v[80:81] op_sel_hi:[1,0,1]
    v_pk_fma_f32 v[82:83], v[122:123], v[104:105], v[82:83] op_sel_hi:[1,0,1]
    v_pk_mul_f32 v[140:141], v[80:81], v[130:131] op_sel_hi:[1,0]
    v_pk_mul_f32 v[142:143], v[82:83], v[130:131] op_sel_hi:[1,0]
    v_exp_f32 v140, v140
    v_exp_f32 v141, v141
    v_exp_f32 v142, v142
    v_exp_f32 v143, v143
    v_pk_fma_f32 v[140:141], v[140:141], v[106:107], v[106:107] op_sel_hi:[1,0,0]
    v_pk_fma_f32 v[142:143], v[142:143], v[106:107], v[106:107] op_sel_hi:[1,0,0]
    v_rcp_f32 v140, v140
    v_rcp_f32 v141, v141
    v_rcp_f32 v142, v142
    v_rcp_f32 v143, v143
    v_pk_mul_f32 v[80:81], v[80:81], v[140:141]
    v_pk_mul_f32 v[82:83], v[82:83], v[142:143]
    v_cvt_pk_bf16_f32 v66, v80, v81
    v_cvt_pk_bf16_f32 v67, v82, v83
    buffer_store_dwordx4 v[64:67], v13, s[44:47], s12 offen sc1
    v_pk_fma_f32 v[68:69], v[116:117], v[108:109], v[68:69] op_sel_hi:[1,0,1]
    v_pk_fma_f32 v[70:71], v[118:119], v[108:109], v[70:71] op_sel_hi:[1,0,1]
    v_pk_mul_f32 v[136:137], v[68:69], v[132:133] op_sel_hi:[1,0]
    v_pk_mul_f32 v[138:139], v[70:71], v[132:133] op_sel_hi:[1,0]
    v_exp_f32 v136, v136
    v_exp_f32 v137, v137
    v_exp_f32 v138, v138
    v_exp_f32 v139, v139
    v_pk_fma_f32 v[136:137], v[136:137], v[110:111], v[110:111] op_sel_hi:[1,0,0]
    v_pk_fma_f32 v[138:139], v[138:139], v[110:111], v[110:111] op_sel_hi:[1,0,0]
    v_rcp_f32 v136, v136
    v_rcp_f32 v137, v137
    v_rcp_f32 v138, v138
    v_rcp_f32 v139, v139
    v_pk_mul_f32 v[68:69], v[68:69], v[136:137]
    v_pk_mul_f32 v[70:71], v[70:71], v[138:139]
    v_cvt_pk_bf16_f32 v68, v68, v69
    v_cvt_pk_bf16_f32 v69, v70, v71
    v_pk_fma_f32 v[84:85], v[120:121], v[108:109], v[84:85] op_sel_hi:[1,0,1]
    v_pk_fma_f32 v[86:87], v[122:123], v[108:109], v[86:87] op_sel_hi:[1,0,1]
    v_pk_mul_f32 v[140:141], v[84:85], v[132:133] op_sel_hi:[1,0]
    v_pk_mul_f32 v[142:143], v[86:87], v[132:133] op_sel_hi:[1,0]
    v_exp_f32 v140, v140
    v_exp_f32 v141, v141
    v_exp_f32 v142, v142
    v_exp_f32 v143, v143
    v_pk_fma_f32 v[140:141], v[140:141], v[110:111], v[110:111] op_sel_hi:[1,0,0]
    v_pk_fma_f32 v[142:143], v[142:143], v[110:111], v[110:111] op_sel_hi:[1,0,0]
    v_rcp_f32 v140, v140
    v_rcp_f32 v141, v141
    v_rcp_f32 v142, v142
    v_rcp_f32 v143, v143
    v_pk_mul_f32 v[84:85], v[84:85], v[140:141]
    v_pk_mul_f32 v[86:87], v[86:87], v[142:143]
    v_cvt_pk_bf16_f32 v70, v84, v85
    v_cvt_pk_bf16_f32 v71, v86, v87
    buffer_store_dwordx4 v[68:71], v14, s[44:47], s12 offen sc1
    v_pk_fma_f32 v[72:73], v[116:117], v[112:113], v[72:73] op_sel_hi:[1,0,1]
    v_pk_fma_f32 v[74:75], v[118:119], v[112:113], v[74:75] op_sel_hi:[1,0,1]
    v_pk_mul_f32 v[136:137], v[72:73], v[134:135] op_sel_hi:[1,0]
    v_pk_mul_f32 v[138:139], v[74:75], v[134:135] op_sel_hi:[1,0]
    v_exp_f32 v136, v136
    v_exp_f32 v137, v137
    v_exp_f32 v138, v138
    v_exp_f32 v139, v139
    v_pk_fma_f32 v[136:137], v[136:137], v[114:115], v[114:115] op_sel_hi:[1,0,0]
    v_pk_fma_f32 v[138:139], v[138:139], v[114:115], v[114:115] op_sel_hi:[1,0,0]
    v_rcp_f32 v136, v136
    v_rcp_f32 v137, v137
    v_rcp_f32 v138, v138
    v_rcp_f32 v139, v139
    v_pk_mul_f32 v[72:73], v[72:73], v[136:137]
    v_pk_mul_f32 v[74:75], v[74:75], v[138:139]
    v_cvt_pk_bf16_f32 v72, v72, v73
    v_cvt_pk_bf16_f32 v73, v74, v75
    v_pk_fma_f32 v[88:89], v[120:121], v[112:113], v[88:89] op_sel_hi:[1,0,1]
    v_pk_fma_f32 v[90:91], v[122:123], v[112:113], v[90:91] op_sel_hi:[1,0,1]
    v_pk_mul_f32 v[140:141], v[88:89], v[134:135] op_sel_hi:[1,0]
    v_pk_mul_f32 v[142:143], v[90:91], v[134:135] op_sel_hi:[1,0]
    v_exp_f32 v140, v140
    v_exp_f32 v141, v141
    v_exp_f32 v142, v142
    v_exp_f32 v143, v143
    v_pk_fma_f32 v[140:141], v[140:141], v[114:115], v[114:115] op_sel_hi:[1,0,0]
    v_pk_fma_f32 v[142:143], v[142:143], v[114:115], v[114:115] op_sel_hi:[1,0,0]
    v_rcp_f32 v140, v140
    v_rcp_f32 v141, v141
    v_rcp_f32 v142, v142
    v_rcp_f32 v143, v143
    v_pk_mul_f32 v[88:89], v[88:89], v[140:141]
    v_pk_mul_f32 v[90:91], v[90:91], v[142:143]
    v_cvt_pk_bf16_f32 v74, v88, v89
    v_cvt_pk_bf16_f32 v75, v90, v91
    buffer_store_dwordx4 v[72:75], v15, s[44:47], s12 offen sc1
Lnoepi:
    s_lshl_b32 s6, s65, 5
    s_add_u32 m0, s23, 0
    s_add_u32 s6, s6, s19
    buffer_load_dwordx4 v16, s[40:43], s6 offen offset:0 lds
    buffer_load_dwordx4 v17, s[40:43], s6 offen offset:1024 lds
    buffer_load_dwordx4 v18, s[40:43], s6 offen offset:2048 lds
    buffer_load_dwordx4 v19, s[40:43], s6 offen offset:3072 lds
    s_cmp_eq_u32 s59, 7
    s_cbranch_scc1 Laf
    s_waitcnt vmcnt(4)
    s_mov_b64 exec, 1
    buffer_store_dword v4, v3, s[44:47], s4 offen sc1
    s_mov_b64 exec, -1
Laf:
    s_waitcnt lgkmcnt(0)
    s_barrier
    s_cmp_eq_u32 s15, 1
    s_cbranch_scc1 LC1
    s_branch LC0
LB:
    s_mov_b32 s29, 0x3fb8aa3b
    v_mov_b32 v32, s28
    v_mul_f32 v32, s29, v32
    v_exp_f32 v32, v32
    s_lshr_b32 s25, s52, 1
    v_lshrrev_b32 v104, 2, v1
    v_lshlrev_b32 v130, 14, v104
    v_lshl_add_u32 v130, v140, 4, v130
    s_lshl_b32 s14, s25, 20
    s_and_b32 s3, s57, 1
    s_lshl_b32 s3, s3, 13
    s_add_u32 s14, s14, s3
    s_lshr_b32 s3, s57, 1
    s_lshl_b32 s3, s3, 6
    s_add_u32 s14, s14, s3
    s_add_u32 s14, s14, 8388608
    s_add_u32 s9, s14, 262144
    s_add_u32 s10, s14, 524288
    s_add_u32 s11, s14, 786432
    v_cvt_pk_bf16_f32 v32, v32, v32
    v_and_b32 v32, 0xffff0000, v32
    v_and_b32 v105, 1, v1
    v_mul_u32_u24 v105, 4608, v105
    v_lshl_add_u32 v105, v104, 4, v105
    v_bfe_u32 v106, v1, 1, 1
    v_lshl_add_u32 v105, v106, 3, v105
    s_lshl_b32 s61, s25, 10
    s_add_u32 s61, s61, 512
    v_add_u32 v129, s61, v105
    s_lshl_b32 s61, s25, 6
    v_add_u32 v104, s61, v1
    v_lshlrev_b32 v127, 4, v104
    v_lshlrev_b32 v104, 3, v104
    v_sub_u32 v104, 2047, v104
    v_cvt_f32_u32 v105, v104
    s_mov_b32 s61, 23296
    v_subrev_f32 v106, 0x0, v105
    v_subrev_f32 v107, 0x3f800000, v105
    v_cvt_pk_bf16_f32 v106, v106, v107
    v_and_b32 v107, 0xffff, v106
    v_lshl_add_u32 v116, v107, 1, s61
    v_lshrrev_b32 v106, 16, v106
    v_lshl_add_u32 v117, v106, 1, s61
    v_subrev_f32 v106, 0x40000000, v105
    v_subrev_f32 v107, 0x40400000, v105
    v_cvt_pk_bf16_f32 v106, v106, v107
    v_and_b32 v107, 0xffff, v106
    v_lshl_add_u32 v118, v107, 1, s61
    v_lshrrev_b32 v106, 16, v106
    v_lshl_add_u32 v119, v106, 1, s61
    v_subrev_f32 v106, 0x40800000, v105
    v_subrev_f32 v107, 0x40a00000, v105
    v_cvt_pk_bf16_f32 v106, v106, v107
    v_and_b32 v107, 0xffff, v106
    v_lshl_add_u32 v120, v107, 1, s61
    v_lshrrev_b32 v106, 16, v106
    v_lshl_add_u32 v121, v106, 1, s61
    v_subrev_f32 v106, 0x40c00000, v105
    v_subrev_f32 v107, 0x40e00000, v105
    v_cvt_pk_bf16_f32 v106, v106, v107
    v_and_b32 v107, 0xffff, v106
    v_lshl_add_u32 v122, v107, 1, s61
    v_lshrrev_b32 v106, 16, v106
    v_lshl_add_u32 v123, v106, 1, s61
    v_subrev_f32 v106, 0x41000000, v105
    v_subrev_f32 v107, 0x41100000, v105
    v_cvt_pk_bf16_f32 v106, v106, v107
    v_and_b32 v107, 0xffff, v106
    v_lshl_add_u32 v124, v107, 1, s61
    v_lshrrev_b32 v106, 16, v106
    v_lshl_add_u32 v125, v106, 1, s61
    v_subrev_f32 v106, 0x41200000, v105
    v_subrev_f32 v107, 0x41300000, v105
    v_cvt_pk_bf16_f32 v106, v106, v107
    v_and_b32 v107, 0xffff, v106
    v_lshl_add_u32 v126, v107, 1, s61
    s_cmp_lg_u32 s25, 3
    s_cbranch_scc1 Lgf
    v_cmp_gt_u32 vcc, 200, v104
    s_mov_b32 s7, 57344
    v_subrev_u32 v106, 0, v104
    v_lshl_add_u32 v106, v106, 1, s7
    v_cndmask_b32 v116, v116, v106, vcc
    v_subrev_u32 v106, 1, v104
    v_lshl_add_u32 v106, v106, 1, s7
    v_cndmask_b32 v117, v117, v106, vcc
    v_subrev_u32 v106, 2, v104
    v_lshl_add_u32 v106, v106, 1, s7
    v_cndmask_b32 v118, v118, v106, vcc
    v_subrev_u32 v106, 3, v104
    v_lshl_add_u32 v106, v106, 1, s7
    v_cndmask_b32 v119, v119, v106, vcc
    v_subrev_u32 v106, 4, v104
    v_lshl_add_u32 v106, v106, 1, s7
    v_cndmask_b32 v120, v120, v106, vcc
    v_subrev_u32 v106, 5, v104
    v_lshl_add_u32 v106, v106, 1, s7
    v_cndmask_b32 v121, v121, v106, vcc
    v_subrev_u32 v106, 6, v104
    v_lshl_add_u32 v106, v106, 1, s7
    v_cndmask_b32 v122, v122, v106, vcc
    v_subrev_u32 v106, 7, v104
    v_lshl_add_u32 v106, v106, 1, s7
    v_cndmask_b32 v123, v123, v106, vcc
    v_subrev_u32 v106, 8, v104
    v_min_u32 v106, 770, v106
    v_lshl_add_u32 v106, v106, 1, s7
    v_cndmask_b32 v124, v124, v106, vcc
    v_subrev_u32 v106, 9, v104
    v_min_u32 v106, 770, v106
    v_lshl_add_u32 v106, v106, 1, s7
    v_cndmask_b32 v125, v125, v106, vcc
    v_subrev_u32 v106, 10, v104
    v_min_u32 v106, 770, v106
    v_lshl_add_u32 v106, v106, 1, s7
    v_cndmask_b32 v126, v126, v106, vcc
Lgf:
    v_lshrrev_b32 v104, 2, v1
    v_mul_u32_u24 v104, 4096, v104
    v_add_u32 v104, v104, v2
    s_mul_i32 s61, s25, 8320
    s_add_u32 s61, s61, 13312
    v_add_u32 v104, s61, v104
    s_mul_i32 s61, s15, 4608
    s_lshl_b32 s3, s26, 8
    s_add_u32 s61, s61, s3
    s_add_u32 s61, s61, 0xffffff80
    v_add_u32 v105, s61, v2
    v_cmp_gt_u32 vcc, 8, v1
    s_mul_i32 s7, s26, 11088
    s_nop 0
    v_cndmask_b32 v128, v105, v104, vcc
    s_lshl_b32 s61, s15, 8
    s_add_u32 s3, s61, s7
    v_lshl_add_u32 v24, v1, 2, s3
    v_mul_u32_u24 v104, 528, v141
    v_lshl_add_u32 v104, v138, 4, v104
    v_add_u32 v25, s7, v104
    v_min_u32 v105, 4, v141
    v_mul_u32_u24 v105, 528, v105
    v_lshl_add_u32 v105, v138, 4, v105
    s_add_u32 s3, s7, 8448
    v_add_u32 v26, s3, v105
    s_mul_i32 s7, s26, 16896
    s_add_u32 s7, s7, 22176
    s_add_u32 s3, s61, s7
    v_lshl_add_u32 v143, v1, 2, s3
    s_mul_i32 s61, s15, 8448
    s_add_u32 s61, s61, s7
    v_add_u32 v27, s61, v104
    s_lshl_b32 s61, s15, 4
    v_add_u32 v104, s61, v141
    s_mul_i32 s27, s26, 1544
    s_add_u32 s27, s27, 57344
    s_mov_b32 s62, 0
    s_mov_b32 s63, 0x0000ffff
    v_lshlrev_b32 v105, 3, v104
    v_lshl_add_u32 v105, v138, 2, v105
    v_lshlrev_b32 v106, 2, v104
    v_add_u32 v106, 256, v106
    v_cndmask_b32 v105, v105, v106, s[62:63]
    s_mov_b32 s63, 0xffff0000
    v_lshlrev_b32 v106, 1, v104
    v_add_u32 v106, 384, v106
    v_cndmask_b32 v105, v105, v106, s[62:63]
    v_mov_b32 v106, 2
    v_mov_b32 v107, 64
    v_cndmask_b32 v106, v106, v107, s[62:63]
    v_lshl_add_u32 v131, v105, 1, s27
    v_lshl_add_u32 v132, v106, 1, v131
    v_min_u32 v105, 1, v138
    v_lshl_add_u32 v105, v105, 7, v104
    v_lshl_add_u32 v133, v105, 1, s27
    v_mov_b32 v134, s27
    v_mov_b32 v135, 60944
    s_add_u32 s0, s0, 128
    s_and_b32 s0, s0, 1023
    s_mul_i32 s1, s0, 1792
    s_add_u32 m0, s18, 65536
    s_add_u32 s1, s1, s17
    buffer_load_dwordx4 v114, s[36:39], s1 offen offset:2048  lds
    buffer_load_dwordx4 v115, s[36:39], s1 offen offset:3072  lds
    s_add_u32 m0, s18, 0xf000
    s_sub_u32 s1, s1, 14336
    buffer_load_dwordx4 v114, s[36:39], s1 offen offset:2048  lds
    buffer_load_dwordx4 v115, s[36:39], s1 offen offset:3072  lds
    s_waitcnt vmcnt(12)
    v_readfirstlane_b32 s60, v64
    v_mov_b32 v3, 0
    s_mul_i32 s60, s60, 0x9E3779B1
    s_add_u32 s60, s60, 0x7F4A7C15
    v_mov_b32 v4, s60
    s_add_u32 s2, s2, 128
    s_and_b32 s2, s2, 1023
    s_add_u32 m0, s18, 65536
    s_add_u32 s5, s16, s2
    buffer_load_dwordx4 v112, s[32:35], s5 offen lds
    buffer_load_dwordx4 v113, s[32:35], s5 offen offset:1024 lds
    s_add_u32 m0, s18, 0xf000
    s_sub_u32 s5, s5, 16384
    buffer_load_dwordx4 v112, s[32:35], s5 offen lds
    buffer_load_dwordx4 v113, s[32:35], s5 offen offset:1024 lds
    s_waitcnt vmcnt(8)
    s_barrier
    s_add_u32 s2, s2, 128
    s_and_b32 s2, s2, 1023
    s_add_u32 m0, s18, 98304
    s_add_u32 s5, s16, s2
    buffer_load_dwordx4 v112, s[32:35], s5 offen lds
    buffer_load_dwordx4 v113, s[32:35], s5 offen offset:1024 lds
    s_add_u32 m0, s18, 0x17000
    s_sub_u32 s5, s5, 16384
    buffer_load_dwordx4 v112, s[32:35], s5 offen lds
    buffer_load_dwordx4 v113, s[32:35], s5 offen offset:1024 lds
    s_add_u32 s0, s0, 128
    s_and_b32 s0, s0, 1023
    s_mul_i32 s1, s0, 1792
    s_add_u32 m0, s18, 98304
    s_add_u32 s1, s1, s17
    buffer_load_dwordx4 v114, s[36:39], s1 offen offset:2048  lds
    buffer_load_dwordx4 v115, s[36:39], s1 offen offset:3072  lds
    s_add_u32 m0, s18, 0x17000
    s_sub_u32 s1, s1, 14336
    buffer_load_dwordx4 v114, s[36:39], s1 offen offset:2048  lds
    buffer_load_dwordx4 v115, s[36:39], s1 offen offset:3072  lds
    s_waitcnt vmcnt(8)
    s_barrier
    s_add_u32 s2, s2, 128
    s_and_b32 s2, s2, 1023
    s_add_u32 m0, s18, 131072
    s_add_u32 s5, s16, s2
    buffer_load_dwordx4 v112, s[32:35], s5 offen lds
    buffer_load_dwordx4 v113, s[32:35], s5 offen offset:1024 lds
    v_lshlrev_b32 v33, 16, v30
    v_lshlrev_b32 v34, 16, v31
    v_max_f32 v33, |v33|, |v34|
    v_max3_f32 v33, |v30|, |v31|, v33
    v_mul_f32 v35, v33, v32
    s_lshl_b32 s8, s15, 4
    s_add_u32 m0, s18, 0x1f000
    s_sub_u32 s5, s5, 16384
    buffer_load_dwordx4 v112, s[32:35], s5 offen lds
    buffer_load_dwordx4 v113, s[32:35], s5 offen offset:1024 lds
    v_lshrrev_b32 v28, s8, v28
    v_lshlrev_b32 v28, 16, v28
    v_max_f32_dpp v35, v35, v35 row_shr:1 row_mask:0xf bank_mask:0xf
    v_lshrrev_b32 v29, s8, v29
    v_lshlrev_b32 v29, 16, v29
    v_max_f32_dpp v35, v35, v35 row_shr:2 row_mask:0xf bank_mask:0xf
    s_add_u32 s0, s0, 128
    s_and_b32 s0, s0, 1023
    s_mul_i32 s1, s0, 1792
    s_add_u32 m0, s18, 131072
    s_add_u32 s1, s1, s17
    buffer_load_dwordx4 v114, s[36:39], s1 offen offset:2048  lds
    buffer_load_dwordx4 v115, s[36:39], s1 offen offset:3072  lds
    v_lshrrev_b32 v30, s8, v30
    v_lshlrev_b32 v30, 16, v30
    v_max_f32_dpp v35, v35, v35 row_shr:4 row_mask:0xf bank_mask:0xf
    v_lshrrev_b32 v31, s8, v31
    v_lshlrev_b32 v31, 16, v31
    v_max_f32_dpp v35, v35, v35 row_shr:8 row_mask:0xf bank_mask:0xf
    s_add_u32 m0, s18, 0x1f000
    s_sub_u32 s1, s1, 14336
    buffer_load_dwordx4 v114, s[36:39], s1 offen offset:2048  lds
    buffer_load_dwordx4 v115, s[36:39], s1 offen offset:3072  lds
    v_mul_f32 v28, s29, v28
    v_exp_f32 v28, v28
    v_max_f32_dpp v35, v35, v35 row_bcast:15 row_mask:0xa bank_mask:0xf
    v_mul_f32 v29, v29, v32
    v_cvt_pk_bf16_f32 v28, v28, v28
    v_max_f32_dpp v35, v35, v35 row_bcast:31 row_mask:0xc bank_mask:0xf
    v_and_b32 v28, 0xffff0000, v28
    v_mul_f32 v29, 0x3e22f983, v29
    v_readlane_b32 s7, v35, 63
    v_mul_f32 v28, v28, v32
    v_mul_f32 v28, 0xbfb8aa3b, v28
    s_lshr_b32 s7, s7, 23
    s_max_u32 s7, s7, 2
    s_min_u32 s7, s7, 250
    s_sub_u32 s22, 253, s7
    s_lshl_b32 s22, s22, 23
    s_waitcnt vmcnt(8)
    s_barrier
    s_add_u32 s2, s2, 128
    s_and_b32 s2, s2, 1023
    s_add_u32 m0, s18, 0
    s_add_u32 s5, s16, s2
    buffer_load_dwordx4 v112, s[32:35], s5 offen lds
    buffer_load_dwordx4 v113, s[32:35], s5 offen offset:1024 lds
    s_add_u32 s21, s7, 2
    s_lshl_b32 s21, s21, 23
    v_mul_f32 v33, 0x3f800000, v28
    s_add_u32 m0, s18, 0xfffff000
    s_sub_u32 s5, s5, 16384
    buffer_load_dwordx4 v112, s[32:35], s5 offen lds
    buffer_load_dwordx4 v113, s[32:35], s5 offen offset:1024 lds
    v_mul_f32 v34, 0x3f800000, v29
    v_exp_f32 v33, v33
    v_fract_f32 v34, v34
    s_add_u32 s0, s0, 128
    s_and_b32 s0, s0, 1023
    s_mul_i32 s1, s0, 1792
    s_add_u32 m0, s18, 0
    s_add_u32 s1, s1, s17
    buffer_load_dwordx4 v114, s[36:39], s1 offen offset:2048  lds
    buffer_load_dwordx4 v115, s[36:39], s1 offen offset:3072  lds
    v_cos_f32 v35, v34
    v_sin_f32 v36, v34
    v_mul_f32 v35, v35, v33
    s_add_u32 m0, s18, 0xfffff000
    s_sub_u32 s1, s1, 14336
    buffer_load_dwordx4 v114, s[36:39], s1 offen offset:2048  lds
    buffer_load_dwordx4 v115, s[36:39], s1 offen offset:3072  lds
    v_mul_f32 v36, v36, v33
    v_mul_f32 v33, 0x43800000, v28
    v_mul_f32 v34, 0x43800000, v29
    s_add_u32 s2, s2, 128
    s_and_b32 s2, s2, 1023
    s_add_u32 m0, s18, 32768
    s_add_u32 s5, s16, s2
    buffer_load_dwordx4 v112, s[32:35], s5 offen lds
    buffer_load_dwordx4 v113, s[32:35], s5 offen offset:1024 lds
    v_exp_f32 v33, v33
    v_fract_f32 v34, v34
    v_cos_f32 v37, v34
    s_add_u32 m0, s18, 0x7000
    s_sub_u32 s5, s5, 16384
    buffer_load_dwordx4 v112, s[32:35], s5 offen lds
    buffer_load_dwordx4 v113, s[32:35], s5 offen offset:1024 lds
    v_sin_f32 v38, v34
    v_mul_f32 v37, v37, v33
    v_mul_f32 v38, v38, v33
    s_add_u32 s0, s0, 128
    s_and_b32 s0, s0, 1023
    s_mul_i32 s1, s0, 1792
    s_add_u32 m0, s18, 32768
    s_add_u32 s1, s1, s17
    buffer_load_dwordx4 v114, s[36:39], s1 offen offset:2048  lds
    buffer_load_dwordx4 v115, s[36:39], s1 offen offset:3072  lds
    v_mul_f32 v39, v30, v32
    v_mul_f32 v40, v31, v32
    v_mul_f32 v39, s22, v39
    s_add_u32 m0, s18, 0x7000
    s_sub_u32 s1, s1, 14336
    buffer_load_dwordx4 v114, s[36:39], s1 offen offset:2048  lds
    buffer_load_dwordx4 v115, s[36:39], s1 offen offset:3072  lds
    v_mul_f32 v40, s22, v40
    v_mul_f32 v41, v39, v35
    v_mul_f32 v42, v39, v36
    v_fma_f32 v41, -v40, v36, v41
    v_fmac_f32 v42, v40, v35
    v_cvt_pk_f16_f32 v59, v39, -v40
    v_mul_f32 v49, v39, v37
    v_mul_f32 v50, v39, v38
    v_fma_f32 v49, -v40, v38, v49
    v_fmac_f32 v50, v40, v37
    v_cvt_pk_f16_f32 v60, v41, -v42
    v_mul_f32 v43, v41, v35
    v_mul_f32 v44, v41, v36
    s_waitcnt vmcnt(16)
    s_barrier
    s_add_u32 s2, s2, 128
    s_and_b32 s2, s2, 1023
    s_add_u32 m0, s18, 65536
    s_add_u32 s5, s16, s2
    buffer_load_dwordx4 v112, s[32:35], s5 offen lds
    buffer_load_dwordx4 v113, s[32:35], s5 offen offset:1024 lds
    v_fma_f32 v43, -v42, v36, v43
    v_fmac_f32 v44, v42, v35
    v_cvt_pk_f16_f32 v67, v49, -v50
    v_mul_f32 v55, v49, v37
    v_mul_f32 v56, v49, v38
    v_fma_f32 v55, -v50, v38, v55
    s_add_u32 m0, s18, 0xf000
    s_sub_u32 s5, s5, 16384
    buffer_load_dwordx4 v112, s[32:35], s5 offen lds
    buffer_load_dwordx4 v113, s[32:35], s5 offen offset:1024 lds
    v_fmac_f32 v56, v50, v37
    v_cvt_pk_f16_f32 v61, v43, -v44
    v_mul_f32 v41, v43, v35
    v_mul_f32 v42, v43, v36
    v_fma_f32 v41, -v44, v36, v41
    v_fmac_f32 v42, v44, v35
    s_add_u32 s0, s0, 128
    s_and_b32 s0, s0, 1023
    s_mul_i32 s1, s0, 1792
    s_add_u32 m0, s18, 65536
    s_add_u32 s1, s1, s17
    buffer_load_dwordx4 v114, s[36:39], s1 offen offset:2048  lds
    buffer_load_dwordx4 v115, s[36:39], s1 offen offset:3072  lds
    v_cvt_pk_f16_f32 v71, v55, -v56
    v_mul_f32 v51, v43, v37
    v_mul_f32 v52, v43, v38
    v_fma_f32 v51, -v44, v38, v51
    v_fmac_f32 v52, v44, v37
    v_cvt_pk_f16_f32 v62, v41, -v42
    s_add_u32 m0, s18, 0xf000
    s_sub_u32 s1, s1, 14336
    buffer_load_dwordx4 v114, s[36:39], s1 offen offset:2048  lds
    buffer_load_dwordx4 v115, s[36:39], s1 offen offset:3072  lds
    v_mul_f32 v49, v55, v37
    v_mul_f32 v50, v55, v38
    v_fma_f32 v49, -v56, v38, v49
    v_fmac_f32 v50, v56, v37
    v_cvt_pk_f16_f32 v68, v51, -v52
    v_mul_f32 v45, v41, v35
    v_mul_f32 v46, v41, v36
    v_fma_f32 v45, -v42, v36, v45
    v_fmac_f32 v46, v42, v35
    v_cvt_pk_f16_f32 v73, v49, -v50
    v_mul_f32 v55, v49, v37
    v_mul_f32 v56, v49, v38
    v_fma_f32 v55, -v50, v38, v55
    v_fmac_f32 v56, v50, v37
    v_cvt_pk_f16_f32 v63, v45, -v46
    v_mul_f32 v41, v45, v35
    s_waitcnt vmcnt(16)
    s_barrier
    s_add_u32 s2, s2, 128
    s_and_b32 s2, s2, 1023
    s_add_u32 m0, s18, 98304
    s_add_u32 s5, s16, s2
    buffer_load_dwordx4 v112, s[32:35], s5 offen lds
    buffer_load_dwordx4 v113, s[32:35], s5 offen offset:1024 lds
    v_mul_f32 v42, v45, v36
    v_fma_f32 v41, -v46, v36, v41
    v_fmac_f32 v42, v46, v35
    v_cvt_pk_f16_f32 v75, v55, -v56
    v_mul_f32 v53, v45, v37
    v_mul_f32 v54, v45, v38
    s_add_u32 m0, s18, 0x17000
    s_sub_u32 s5, s5, 16384
    buffer_load_dwordx4 v112, s[32:35], s5 offen lds
    buffer_load_dwordx4 v113, s[32:35], s5 offen offset:1024 lds
    v_fma_f32 v53, -v46, v38, v53
    v_fmac_f32 v54, v46, v37
    v_cvt_pk_f16_f32 v64, v41, -v42
    v_mul_f32 v49, v55, v37
    v_mul_f32 v50, v55, v38
    v_fma_f32 v49, -v56, v38, v49
    s_add_u32 s0, s0, 128
    s_and_b32 s0, s0, 1023
    s_mul_i32 s1, s0, 1792
    s_add_u32 m0, s18, 98304
    s_add_u32 s1, s1, s17
    buffer_load_dwordx4 v114, s[36:39], s1 offen offset:2048  lds
    buffer_load_dwordx4 v115, s[36:39], s1 offen offset:3072  lds
    v_fmac_f32 v50, v56, v37
    v_cvt_pk_f16_f32 v69, v53, -v54
    v_mul_f32 v47, v41, v35
    v_mul_f32 v48, v41, v36
    v_fma_f32 v47, -v42, v36, v47
    v_fmac_f32 v48, v42, v35
    s_add_u32 m0, s18, 0x17000
    s_sub_u32 s1, s1, 14336
    buffer_load_dwordx4 v114, s[36:39], s1 offen offset:2048  lds
    buffer_load_dwordx4 v115, s[36:39], s1 offen offset:3072  lds
    v_cvt_pk_f16_f32 v76, v49, -v50
    v_mul_f32 v57, v53, v37
    v_mul_f32 v58, v53, v38
    v_fma_f32 v57, -v54, v38, v57
    v_fmac_f32 v58, v54, v37
    v_cvt_pk_f16_f32 v65, v47, -v48
    v_mul_f32 v55, v49, v37
    v_mul_f32 v56, v49, v38
    v_fma_f32 v55, -v50, v38, v55
    v_fmac_f32 v56, v50, v37
    v_cvt_pk_f16_f32 v72, v57, -v58
    v_mul_f32 v41, v47, v35
    v_mul_f32 v42, v47, v36
    v_fma_f32 v41, -v48, v36, v41
    v_fmac_f32 v42, v48, v35
    v_cvt_pk_f16_f32 v77, v55, -v56
    s_waitcnt vmcnt(16)
    s_barrier
    s_lshl_b32 s6, s64, 5
    s_add_u32 m0, s23, 65536
    s_add_u32 s6, s6, s19
    buffer_load_dwordx4 v16, s[40:43], s6 offen offset:0 lds
    buffer_load_dwordx4 v17, s[40:43], s6 offen offset:1024 lds
    buffer_load_dwordx4 v18, s[40:43], s6 offen offset:2048 lds
    buffer_load_dwordx4 v19, s[40:43], s6 offen offset:3072 lds
    v_mul_f32 v51, v47, v37
    v_mul_f32 v52, v47, v38
    v_fma_f32 v51, -v48, v38, v51
    v_fmac_f32 v52, v48, v37
    v_cvt_pk_f16_f32 v66, v41, -v42
    v_mul_f32 v53, v57, v37
    v_mul_f32 v54, v57, v38
    v_fma_f32 v53, -v58, v38, v53
    v_fmac_f32 v54, v58, v37
    v_cvt_pk_f16_f32 v70, v51, -v52
    v_mul_f32 v49, v55, v37
    v_mul_f32 v50, v55, v38
    v_fma_f32 v49, -v56, v38, v49
    v_fmac_f32 v50, v56, v37
    v_cvt_pk_f16_f32 v74, v53, -v54
    v_mul_f32 v55, v49, v37
    v_mul_f32 v56, v49, v38
    v_fma_f32 v55, -v50, v38, v55
    v_fmac_f32 v56, v50, v37
    v_cvt_pk_f16_f32 v78, v49, -v50
    v_cvt_pk_f16_f32 v79, v55, -v56
    v_mul_f32 v33, 0x41000000, v28
    v_mul_f32 v34, 0x41000000, v29
    v_exp_f32 v33, v33
    v_fract_f32 v34, v34
    v_cos_f32 v35, v34
    v_sin_f32 v36, v34
    v_mul_f32 v35, v35, v33
    v_mul_f32 v36, v36, v33
    v_mul_f32 v33, 0x42000000, v28
    v_mul_f32 v34, 0x42000000, v29
    v_exp_f32 v33, v33
    v_fract_f32 v34, v34
    v_cos_f32 v37, v34
    v_sin_f32 v38, v34
    v_mul_f32 v37, v37, v33
    v_mul_f32 v38, v38, v33
    v_mov_b32 v80, 0x3c00
    v_cvt_pk_f16_f32 v81, v35, v36
    v_cvt_pk_f16_f32 v84, v37, v38
    v_mul_f32 v39, v35, v35
    s_waitcnt vmcnt(12)
    s_barrier
    s_lshl_b32 s6, s64, 5
    s_add_u32 m0, s23, 61440
    s_add_u32 s6, s6, s19
    s_sub_u32 s6, s6, 229376
    buffer_load_dwordx4 v16, s[40:43], s6 offen offset:0 lds
    buffer_load_dwordx4 v17, s[40:43], s6 offen offset:1024 lds
    buffer_load_dwordx4 v18, s[40:43], s6 offen offset:2048 lds
    buffer_load_dwordx4 v19, s[40:43], s6 offen offset:3072 lds
    v_mul_f32 v40, v35, v36
    v_fma_f32 v39, -v36, v36, v39
    v_fmac_f32 v40, v36, v35
    v_mul_f32 v43, v37, v37
    v_mul_f32 v44, v37, v38
    v_fma_f32 v43, -v38, v38, v43
    v_fmac_f32 v44, v38, v37
    v_cvt_pk_f16_f32 v82, v39, v40
    v_mul_f32 v41, v39, v35
    v_mul_f32 v42, v39, v36
    v_fma_f32 v41, -v40, v36, v41
    v_fmac_f32 v42, v40, v35
    v_cvt_pk_f16_f32 v88, v43, v44
    v_cvt_pk_f16_f32 v83, v41, v42
    v_mul_f32 v45, v43, v37
    v_mul_f32 v46, v43, v38
    v_fma_f32 v45, -v44, v38, v45
    v_fmac_f32 v46, v44, v37
    v_pk_mul_f16 v85, v84, v81 op_sel:[0,0] op_sel_hi:[0,1]
    v_pk_mul_f16 v86, v84, v82 op_sel:[0,0] op_sel_hi:[0,1]
    v_pk_mul_f16 v87, v84, v83 op_sel:[0,0] op_sel_hi:[0,1]
    v_pk_fma_f16 v85, v84, v81, v85 op_sel:[1,1,0] op_sel_hi:[1,0,1] neg_lo:[0,1,0]
    v_pk_fma_f16 v86, v84, v82, v86 op_sel:[1,1,0] op_sel_hi:[1,0,1] neg_lo:[0,1,0]
    v_pk_fma_f16 v87, v84, v83, v87 op_sel:[1,1,0] op_sel_hi:[1,0,1] neg_lo:[0,1,0]
    v_cvt_pk_f16_f32 v92, v45, v46
    v_mul_f32 v43, v45, v37
    v_mul_f32 v44, v45, v38
    s_waitcnt vmcnt(8)
    s_barrier
    v_fma_f32 v43, -v46, v38, v43
    v_fmac_f32 v44, v46, v37
    v_pk_mul_f16 v89, v88, v81 op_sel:[0,0] op_sel_hi:[0,1]
    v_pk_mul_f16 v90, v88, v82 op_sel:[0,0] op_sel_hi:[0,1]
    v_pk_mul_f16 v91, v88, v83 op_sel:[0,0] op_sel_hi:[0,1]
    v_pk_fma_f16 v89, v88, v81, v89 op_sel:[1,1,0] op_sel_hi:[1,0,1] neg_lo:[0,1,0]
    v_pk_fma_f16 v90, v88, v82, v90 op_sel:[1,1,0] op_sel_hi:[1,0,1] neg_lo:[0,1,0]
    v_pk_fma_f16 v91, v88, v83, v91 op_sel:[1,1,0] op_sel_hi:[1,0,1] neg_lo:[0,1,0]
    v_cvt_pk_f16_f32 v96, v43, v44
    v_mul_f32 v45, v43, v37
    v_mul_f32 v46, v43, v38
    v_fma_f32 v45, -v44, v38, v45
    v_fmac_f32 v46, v44, v37
    v_pk_mul_f16 v93, v92, v81 op_sel:[0,0] op_sel_hi:[0,1]
    v_pk_mul_f16 v94, v92, v82 op_sel:[0,0] op_sel_hi:[0,1]
    v_pk_mul_f16 v95, v92, v83 op_sel:[0,0] op_sel_hi:[0,1]
    v_pk_fma_f16 v93, v92, v81, v93 op_sel:[1,1,0] op_sel_hi:[1,0,1] neg_lo:[0,1,0]
    v_pk_fma_f16 v94, v92, v82, v94 op_sel:[1,1,0] op_sel_hi:[1,0,1] neg_lo:[0,1,0]
    v_pk_fma_f16 v95, v92, v83, v95 op_sel:[1,1,0] op_sel_hi:[1,0,1] neg_lo:[0,1,0]
    v_cvt_pk_f16_f32 v100, v45, v46
    v_mul_f32 v43, v45, v37
    v_mul_f32 v44, v45, v38
    v_fma_f32 v43, -v46, v38, v43
    v_fmac_f32 v44, v46, v37
    v_pk_mul_f16 v97, v96, v81 op_sel:[0,0] op_sel_hi:[0,1]
    v_pk_mul_f16 v98, v96, v82 op_sel:[0,0] op_sel_hi:[0,1]
    v_pk_mul_f16 v99, v96, v83 op_sel:[0,0] op_sel_hi:[0,1]
    v_pk_fma_f16 v97, v96, v81, v97 op_sel:[1,1,0] op_sel_hi:[1,0,1] neg_lo:[0,1,0]
    v_pk_fma_f16 v98, v96, v82, v98 op_sel:[1,1,0] op_sel_hi:[1,0,1] neg_lo:[0,1,0]
    v_pk_fma_f16 v99, v96, v83, v99 op_sel:[1,1,0] op_sel_hi:[1,0,1] neg_lo:[0,1,0]
    v_cvt_pk_f16_f32 v104, v43, v44
    v_mul_f32 v45, v43, v37
    v_mul_f32 v46, v43, v38
    v_fma_f32 v45, -v44, v38, v45
    v_fmac_f32 v46, v44, v37
    v_pk_mul_f16 v101, v100, v81 op_sel:[0,0] op_sel_hi:[0,1]
    v_pk_mul_f16 v102, v100, v82 op_sel:[0,0] op_sel_hi:[0,1]
    v_pk_mul_f16 v103, v100, v83 op_sel:[0,0] op_sel_hi:[0,1]
    v_pk_fma_f16 v101, v100, v81, v101 op_sel:[1,1,0] op_sel_hi:[1,0,1] neg_lo:[0,1,0]
    v_pk_fma_f16 v102, v100, v82, v102 op_sel:[1,1,0] op_sel_hi:[1,0,1] neg_lo:[0,1,0]
    v_pk_fma_f16 v103, v100, v83, v103 op_sel:[1,1,0] op_sel_hi:[1,0,1] neg_lo:[0,1,0]
    v_cvt_pk_f16_f32 v108, v45, v46
    v_pk_mul_f16 v105, v104, v81 op_sel:[0,0] op_sel_hi:[0,1]
    v_pk_mul_f16 v106, v104, v82 op_sel:[0,0] op_sel_hi:[0,1]
    v_pk_mul_f16 v107, v104, v83 op_sel:[0,0] op_sel_hi:[0,1]
    v_pk_fma_f16 v105, v104, v81, v105 op_sel:[1,1,0] op_sel_hi:[1,0,1] neg_lo:[0,1,0]
    v_pk_fma_f16 v106, v104, v82, v106 op_sel:[1,1,0] op_sel_hi:[1,0,1] neg_lo:[0,1,0]
    v_pk_fma_f16 v107, v104, v83, v107 op_sel:[1,1,0] op_sel_hi:[1,0,1] neg_lo:[0,1,0]
    v_pk_mul_f16 v109, v108, v81 op_sel:[0,0] op_sel_hi:[0,1]
    v_pk_mul_f16 v110, v108, v82 op_sel:[0,0] op_sel_hi:[0,1]
    v_pk_mul_f16 v111, v108, v83 op_sel:[0,0] op_sel_hi:[0,1]
    v_pk_fma_f16 v109, v108, v81, v109 op_sel:[1,1,0] op_sel_hi:[1,0,1] neg_lo:[0,1,0]
    v_pk_fma_f16 v110, v108, v82, v110 op_sel:[1,1,0] op_sel_hi:[1,0,1] neg_lo:[0,1,0]
    v_pk_fma_f16 v111, v108, v83, v111 op_sel:[1,1,0] op_sel_hi:[1,0,1] neg_lo:[0,1,0]
    ds_write_b32 v135, v3
    s_waitcnt lgkmcnt(0)
    s_barrier
    buffer_load_dwordx4 v[28:31], v130, s[44:47], s14 offen sc1
    buffer_load_dwordx4 v[32:35], v130, s[44:47], s9 offen sc1
    buffer_load_dwordx4 v[36:39], v130, s[44:47], s10 offen sc1
    buffer_load_dwordx4 v[40:43], v130, s[44:47], s11 offen sc1
    ds_write_b32 v24, v59 offset:0
    ds_write_b32 v24, v60 offset:528
    ds_write_b32 v24, v61 offset:1056
    ds_write_b32 v24, v62 offset:1584
    ds_write_b32 v24, v63 offset:2112
    ds_write_b32 v24, v64 offset:2640
    ds_write_b32 v24, v65 offset:3168
    ds_write_b32 v24, v66 offset:3696
    ds_write_b32 v24, v67 offset:4224
    ds_write_b32 v24, v68 offset:4752
    ds_write_b32 v24, v69 offset:5280
    ds_write_b32 v24, v70 offset:5808
    ds_write_b32 v24, v71 offset:6336
    ds_write_b32 v24, v72 offset:6864
    ds_write_b32 v24, v73 offset:7392
    ds_write_b32 v24, v74 offset:7920
    ds_write_b32 v24, v75 offset:8448
    ds_write_b32 v24, v76 offset:8976
    ds_write_b32 v24, v77 offset:9504
    ds_write_b32 v24, v78 offset:10032
    ds_write_b32 v24, v79 offset:10560
    ds_write_b32 v143, v80 offset:0
    ds_write_b32 v143, v81 offset:528
    ds_write_b32 v143, v82 offset:1056
    ds_write_b32 v143, v83 offset:1584
    ds_write_b32 v143, v84 offset:2112
    ds_write_b32 v143, v85 offset:2640
    ds_write_b32 v143, v86 offset:3168
    ds_write_b32 v143, v87 offset:3696
    ds_write_b32 v143, v88 offset:4224
    ds_write_b32 v143, v89 offset:4752
    ds_write_b32 v143, v90 offset:5280
    ds_write_b32 v143, v91 offset:5808
    ds_write_b32 v143, v92 offset:6336
    ds_write_b32 v143, v93 offset:6864
    ds_write_b32 v143, v94 offset:7392
    ds_write_b32 v143, v95 offset:7920
    ds_write_b32 v143, v96 offset:8448
    ds_write_b32 v143, v97 offset:8976
    ds_write_b32 v143, v98 offset:9504
    ds_write_b32 v143, v99 offset:10032
    ds_write_b32 v143, v100 offset:10560
    ds_write_b32 v143, v101 offset:11088
    ds_write_b32 v143, v102 offset:11616
    ds_write_b32 v143, v103 offset:12144
    ds_write_b32 v143, v104 offset:12672
    ds_write_b32 v143, v105 offset:13200
    ds_write_b32 v143, v106 offset:13728
    ds_write_b32 v143, v107 offset:14256
    ds_write_b32 v143, v108 offset:14784
    ds_write_b32 v143, v109 offset:15312
    ds_write_b32 v143, v110 offset:15840
    ds_write_b32 v143, v111 offset:16368
    ds_write_b32 v134, v3 offset:1540
    s_waitcnt lgkmcnt(0)
    v_mov_b32 v142, 1
    s_mov_b64 exec, 1
    ds_add_u32 v135, v142
    s_mov_b64 exec, -1
    s_mov_b32 s61, 0
Lbs1:
    ds_read_b32 v142, v135
    s_add_u32 s61, s61, 1
    s_waitcnt lgkmcnt(0)
    v_cmp_gt_u32 vcc, 4, v142
    s_cmp_gt_u32 s61, 0x100000
    s_cbranch_scc1 Lbso1
    s_cbranch_vccnz Lbs1
Lbso1:
    ds_read_b128 v[44:47], v25 offset:0
    ds_read_b128 v[48:51], v26 offset:0
    ds_read_b128 v[52:55], v27 offset:0
    ds_read_b128 v[56:59], v25 offset:64
    ds_read_b128 v[60:63], v26 offset:64
    ds_read_b128 v[64:67], v27 offset:64
    ds_read_b128 v[68:71], v25 offset:128
    ds_read_b128 v[72:75], v26 offset:128
    ds_read_b128 v[76:79], v27 offset:128
    ds_read_b128 v[80:83], v25 offset:192
    ds_read_b128 v[84:87], v26 offset:192
    ds_read_b128 v[88:91], v27 offset:192
    ds_read_b128 v[92:95], v25 offset:256
    ds_read_b128 v[96:99], v26 offset:256
    ds_read_b128 v[100:103], v27 offset:256
    s_waitcnt lgkmcnt(12)
    v_mfma_f32_16x16x32_f16 v[104:107], v[44:47], v[52:55], 0
    v_mfma_f32_16x16x32_f16 v[108:111], v[48:51], v[52:55], 0
    ds_read_b128 v[44:47], v25 offset:320
    ds_read_b128 v[48:51], v26 offset:320
    ds_read_b128 v[52:55], v27 offset:320
    s_waitcnt lgkmcnt(12)
    v_mfma_f32_16x16x32_f16 v[104:107], v[56:59], v[64:67], v[104:107]
    v_mfma_f32_16x16x32_f16 v[108:111], v[60:63], v[64:67], v[108:111]
    ds_read_b128 v[56:59], v25 offset:384
    ds_read_b128 v[60:63], v26 offset:384
    ds_read_b128 v[64:67], v27 offset:384
    s_waitcnt lgkmcnt(12)
    v_mfma_f32_16x16x32_f16 v[104:107], v[68:71], v[76:79], v[104:107]
    v_mfma_f32_16x16x32_f16 v[108:111], v[72:75], v[76:79], v[108:111]
    ds_read_b128 v[68:71], v25 offset:448
    ds_read_b128 v[72:75], v26 offset:448
    ds_read_b128 v[76:79], v27 offset:448
    s_waitcnt lgkmcnt(12)
    v_mfma_f32_16x16x32_f16 v[104:107], v[80:83], v[88:91], v[104:107]
    v_mfma_f32_16x16x32_f16 v[108:111], v[84:87], v[88:91], v[108:111]
    s_waitcnt lgkmcnt(9)
    v_mfma_f32_16x16x32_f16 v[104:107], v[92:95], v[100:103], v[104:107]
    v_mfma_f32_16x16x32_f16 v[108:111], v[96:99], v[100:103], v[108:111]
    s_waitcnt lgkmcnt(6)
    v_mfma_f32_16x16x32_f16 v[104:107], v[44:47], v[52:55], v[104:107]
    v_mfma_f32_16x16x32_f16 v[108:111], v[48:51], v[52:55], v[108:111]
    s_waitcnt lgkmcnt(3)
    v_mfma_f32_16x16x32_f16 v[104:107], v[56:59], v[64:67], v[104:107]
    v_mfma_f32_16x16x32_f16 v[108:111], v[60:63], v[64:67], v[108:111]
    s_waitcnt lgkmcnt(0)
    v_mfma_f32_16x16x32_f16 v[104:107], v[68:71], v[76:79], v[104:107]
    v_mfma_f32_16x16x32_f16 v[108:111], v[72:75], v[76:79], v[108:111]
    s_nop 6
    v_mul_f32 v104, s21, v104
    v_mul_f32 v105, s21, v105
    v_mul_f32 v106, s21, v106
    v_mul_f32 v107, s21, v107
    v_mul_f32 v108, s21, v108
    v_mul_f32 v109, s21, v109
    v_mul_f32 v110, s21, v110
    v_mul_f32 v111, s21, v111
    v_cvt_pk_bf16_f32 v104, v104, v105
    v_cvt_pk_bf16_f32 v105, v106, v107
    v_cvt_pk_bf16_f32 v106, v108, v109
    v_cvt_pk_bf16_f32 v107, v110, v111
    ds_write_b32 v131, v104
    ds_write_b32 v132, v105
    ds_write_b16 v133, v106 offset:1024
    ds_write_b16_d16_hi v133, v106 offset:1088
    ds_write_b16 v133, v107 offset:1152
    ds_write_b16_d16_hi v133, v107 offset:1216
    s_waitcnt lgkmcnt(0)
    v_mov_b32 v142, 1
    s_mov_b64 exec, 1
    ds_add_u32 v135, v142
    s_mov_b64 exec, -1
    s_mov_b32 s61, 0
Lbs2:
    ds_read_b32 v142, v135
    s_add_u32 s61, s61, 1
    s_waitcnt lgkmcnt(0)
    v_cmp_gt_u32 vcc, 8, v142
    s_cmp_gt_u32 s61, 0x100000
    s_cbranch_scc1 Lbso2
    s_cbranch_vccnz Lbs2
Lbso2:
    ds_read_u16 v44, v116 offset:0
    ds_read_u16 v45, v117 offset:0
    ds_read_u16 v46, v118 offset:0
    ds_read_u16 v47, v119 offset:0
    ds_read_u16 v48, v120 offset:0
    ds_read_u16 v49, v121 offset:0
    ds_read_u16 v50, v122 offset:0
    ds_read_u16 v51, v123 offset:0
    ds_read_u16 v52, v124 offset:0
    ds_read_u16 v53, v125 offset:0
    ds_read_u16 v54, v126 offset:0
    ds_read_u16 v56, v116 offset:1544
    ds_read_u16 v57, v117 offset:1544
    ds_read_u16 v58, v118 offset:1544
    ds_read_u16 v59, v119 offset:1544
    ds_read_u16 v60, v120 offset:1544
    ds_read_u16 v61, v121 offset:1544
    ds_read_u16 v62, v122 offset:1544
    ds_read_u16 v63, v123 offset:1544
    ds_read_u16 v64, v124 offset:1544
    ds_read_u16 v65, v125 offset:1544
    ds_read_u16 v66, v126 offset:1544
    v_mov_b32 v136, 0
    v_mov_b32 v137, 0
    v_mov_b32 v138, 0
    v_mov_b32 v139, 0
    s_mov_b64 exec, 0xffffff
    ds_write_b128 v128, v[136:139]
    s_mov_b64 exec, -1
    s_waitcnt lgkmcnt(12)
    v_lshl_or_b32 v68, v45, 16, v44
    v_lshl_or_b32 v69, v47, 16, v46
    v_lshl_or_b32 v70, v49, 16, v48
    v_lshl_or_b32 v71, v51, 16, v50
    ds_write_b128 v127, v[68:71] offset:9216
    v_lshl_or_b32 v72, v46, 16, v45
    v_lshl_or_b32 v73, v48, 16, v47
    v_lshl_or_b32 v74, v50, 16, v49
    v_lshl_or_b32 v75, v52, 16, v51
    ds_write_b128 v127, v[72:75] offset:13376
    v_lshl_or_b32 v76, v47, 16, v46
    v_lshl_or_b32 v77, v49, 16, v48
    v_lshl_or_b32 v78, v51, 16, v50
    v_lshl_or_b32 v79, v53, 16, v52
    ds_write_b128 v127, v[76:79] offset:17536
    v_lshl_or_b32 v80, v48, 16, v47
    v_lshl_or_b32 v81, v50, 16, v49
    v_lshl_or_b32 v82, v52, 16, v51
    v_lshl_or_b32 v83, v54, 16, v53
    ds_write_b128 v127, v[80:83] offset:21696
    s_waitcnt lgkmcnt(5)
    v_lshl_or_b32 v84, v57, 16, v56
    v_lshl_or_b32 v85, v59, 16, v58
    v_lshl_or_b32 v86, v61, 16, v60
    v_lshl_or_b32 v87, v63, 16, v62
    ds_write_b128 v127, v[84:87] offset:25856
    v_lshl_or_b32 v88, v58, 16, v57
    v_lshl_or_b32 v89, v60, 16, v59
    v_lshl_or_b32 v90, v62, 16, v61
    v_lshl_or_b32 v91, v64, 16, v63
    ds_write_b128 v127, v[88:91] offset:30016
    v_lshl_or_b32 v92, v59, 16, v58
    v_lshl_or_b32 v93, v61, 16, v60
    v_lshl_or_b32 v94, v63, 16, v62
    v_lshl_or_b32 v95, v65, 16, v64
    ds_write_b128 v127, v[92:95] offset:34176
    v_lshl_or_b32 v96, v60, 16, v59
    v_lshl_or_b32 v97, v62, 16, v61
    v_lshl_or_b32 v98, v64, 16, v63
    v_lshl_or_b32 v99, v66, 16, v65
    ds_write_b128 v127, v[96:99] offset:38336
    s_waitcnt vmcnt(0)
    s_mov_b32 s61, 0
Ltc1:
    v_xor_b32 v136, v29, v4
    v_xor_b32 v137, v31, v4
    v_or_b32 v136, v136, v137
    v_xor_b32 v137, v33, v4
    v_or_b32 v136, v136, v137
    v_xor_b32 v137, v35, v4
    v_or_b32 v136, v136, v137
    v_xor_b32 v137, v37, v4
    v_or_b32 v136, v136, v137
    v_xor_b32 v137, v39, v4
    v_or_b32 v136, v136, v137
    v_xor_b32 v137, v41, v4
    v_or_b32 v136, v136, v137
    v_xor_b32 v137, v43, v4
    v_or_b32 v136, v136, v137
    v_cmp_ne_u32 vcc, 0, v136
    s_cbranch_vccz Ltco1
    s_add_u32 s61, s61, 1
    s_cmp_gt_u32 s61, 20000
    s_cbranch_scc1 Ltco1
    buffer_load_dwordx4 v[28:31], v130, s[44:47], s14 offen sc1
    buffer_load_dwordx4 v[32:35], v130, s[44:47], s9 offen sc1
    buffer_load_dwordx4 v[36:39], v130, s[44:47], s10 offen sc1
    buffer_load_dwordx4 v[40:43], v130, s[44:47], s11 offen sc1
    s_waitcnt vmcnt(0)
    s_branch Ltc1
Ltco1:
    ds_write2_b32 v129, v28, v30 offset0:0 offset1:1
    ds_write2_b32 v129, v32, v34 offset0:64 offset1:65
    ds_write2_b32 v129, v36, v38 offset0:128 offset1:129
    ds_write2_b32 v129, v40, v42 offset0:192 offset1:193
    s_lshl_b32 s6, s65, 5
    s_add_u32 m0, s23, 0
    s_add_u32 s6, s6, s19
    buffer_load_dwordx4 v16, s[40:43], s6 offen offset:0 lds
    buffer_load_dwordx4 v17, s[40:43], s6 offen offset:1024 lds
    buffer_load_dwordx4 v18, s[40:43], s6 offen offset:2048 lds
    buffer_load_dwordx4 v19, s[40:43], s6 offen offset:3072 lds
    s_waitcnt lgkmcnt(0)
    s_barrier
    s_cmp_eq_u32 s15, 1
    s_cbranch_scc1 LC1
LC0:
    ds_read_b64 v[40:41], v5 offset:192
    ds_read_b64 v[42:43], v5 offset:200
    ds_read_b128 v[44:47], v6 offset:192
    ds_read_b64 v[48:49], v5 offset:704
    ds_read_b64 v[50:51], v5 offset:712
    ds_read_b128 v[52:55], v6 offset:704
    ds_read_b64 v[56:57], v5 offset:1216
    ds_read_b64 v[58:59], v5 offset:1224
    ds_read_b128 v[60:63], v6 offset:1216
    ds_read_b64 v[64:65], v5 offset:1728
    ds_read_b64 v[66:67], v5 offset:1736
    ds_read_b128 v[68:71], v6 offset:1728
    ds_read_b64 v[72:73], v5 offset:2240
    ds_read_b64 v[74:75], v5 offset:2248
    s_or_b32 s61, s57, s52
    s_cmp_lg_u32 s61, 0
    s_cbranch_scc1 Lnoe
    s_mov_b32 s61, 0xc80000
    s_mov_b64 exec, 1
    buffer_store_dword v4, v3, s[44:47], s61 offen sc1
    s_mov_b64 exec, -1
Lnoe:
    s_waitcnt lgkmcnt(8)
    v_mfma_f32_16x16x32_bf16 v[36:39], v[40:43], v[44:47], 0
    ds_read_b128 v[128:131], v6 offset:2240
    s_lshl_b32 s6, s66, 5
    s_add_u32 m0, s23, 32768
    s_add_u32 s6, s6, s19
    buffer_load_dwordx4 v16, s[40:43], s6 offen offset:0 lds
    buffer_load_dwordx4 v17, s[40:43], s6 offen offset:1024 lds
    buffer_load_dwordx4 v18, s[40:43], s6 offen offset:2048 lds
    buffer_load_dwordx4 v19, s[40:43], s6 offen offset:3072 lds
    v_mfma_f32_16x16x32_bf16 v[36:39], v[48:51], v[52:55], v[36:39]
    ds_read_b64 v[132:133], v5 offset:2752
    ds_read_b64 v[134:135], v5 offset:2760
    v_add_u32 v20, 0x10000, v20
    v_add_u32 v21, 0x10000, v21
    v_add_u32 v22, 0x10000, v22
    v_add_u32 v23, 0x10000, v23
    ds_read_b64_tr_b16 a[0:1], v20 offset:0
    ds_read_b64_tr_b16 a[2:3], v20 offset:2048
    ds_read_b64_tr_b16 a[4:5], v21 offset:0
    ds_read_b64_tr_b16 a[6:7], v21 offset:2048
    ds_read_b64_tr_b16 a[8:9], v22 offset:0
    ds_read_b64_tr_b16 a[10:11], v22 offset:2048
    ds_read_b64_tr_b16 a[12:13], v23 offset:0
    ds_read_b64_tr_b16 a[14:15], v23 offset:2048
    s_waitcnt lgkmcnt(13)
    v_mfma_f32_16x16x32_bf16 v[36:39], v[56:59], v[60:63], v[36:39]
    ds_read_b128 v[136:139], v6 offset:2752
    v_mfma_f32_16x16x32_bf16 v[36:39], v[64:67], v[68:71], v[36:39]
    ds_read_b64 v[140:141], v5 offset:3264
    ds_read_b64 v[142:143], v5 offset:3272
    s_waitcnt lgkmcnt(13)
    v_mfma_f32_16x16x32_bf16 v[32:35], v[64:67], v[44:47], 0
    ds_read_b128 v[40:43], v6 offset:3264
    s_waitcnt lgkmcnt(4)
    s_lshl_b32 s6, s67, 5
    s_add_u32 m0, s23, 65536
    s_add_u32 s6, s6, s19
    buffer_load_dwordx4 v16, s[40:43], s6 offen offset:0 lds
    buffer_load_dwordx4 v17, s[40:43], s6 offen offset:1024 lds
    buffer_load_dwordx4 v18, s[40:43], s6 offen offset:2048 lds
    buffer_load_dwordx4 v19, s[40:43], s6 offen offset:3072 lds
    v_mfma_f32_16x16x32_bf16 v[36:39], v[72:75], v[128:131], v[36:39]
    ds_read_b64 v[48:49], v5 offset:3776
    ds_read_b64 v[50:51], v5 offset:3784
    v_mfma_f32_16x16x32_bf16 v[32:35], v[72:75], v[52:55], v[32:35]
    ds_read_b128 v[56:59], v6 offset:3776
    v_mfma_f32_16x16x32_bf16 v[28:31], v[72:75], v[44:47], 0
    ds_read_b64 v[64:65], v5 offset:128
    ds_read_b64 v[66:67], v5 offset:136
    s_waitcnt lgkmcnt(8)
    v_mfma_f32_16x16x32_bf16 v[36:39], v[132:135], v[136:139], v[36:39]
    ds_read_b128 v[72:75], v6 offset:128
    v_mfma_f32_16x16x32_bf16 v[32:35], v[132:135], v[60:63], v[32:35]
    ds_read_b64 v[136:137], v5 offset:640
    ds_read_b64 v[138:139], v5 offset:648
    s_waitcnt lgkmcnt(8)
    v_mfma_f32_16x16x32_bf16 v[28:31], v[132:135], v[52:55], v[28:31]
    v_mfma_f32_16x16x32_bf16 v[36:39], v[140:143], v[40:43], v[36:39]
    ds_read_b128 v[132:135], v6 offset:640
    v_mfma_f32_16x16x32_bf16 v[32:35], v[140:143], v[68:71], v[32:35]
    ds_read_b64 v[52:53], v5 offset:1152
    ds_read_b64 v[54:55], v5 offset:1160
    v_mfma_f32_16x16x32_bf16 v[28:31], v[140:143], v[60:63], v[28:31]
    ds_read_b128 v[40:43], v6 offset:1152
    s_waitcnt lgkmcnt(9)
    v_mfma_f32_16x16x32_bf16 v[36:39], v[48:51], v[56:59], v[36:39]
    ds_read_b64 v[140:141], v5 offset:1664
    ds_read_b64 v[142:143], v5 offset:1672
    s_waitcnt vmcnt(8)
    v_add_u32 v20, 0xffff0000, v20
    v_add_u32 v21, 0xffff0000, v21
    v_add_u32 v22, 0xffff0000, v22
    v_add_u32 v23, 0xffff0000, v23
    ds_read_b64_tr_b16 a[16:17], v20 offset:0
    ds_read_b64_tr_b16 a[18:19], v20 offset:2048
    ds_read_b64_tr_b16 a[20:21], v21 offset:0
    ds_read_b64_tr_b16 a[22:23], v21 offset:2048
    ds_read_b64_tr_b16 a[24:25], v22 offset:0
    ds_read_b64_tr_b16 a[26:27], v22 offset:2048
    ds_read_b64_tr_b16 a[28:29], v23 offset:0
    ds_read_b64_tr_b16 a[30:31], v23 offset:2048
    s_waitcnt vmcnt(4)
    ds_read_b64_tr_b16 a[32:33], v20 offset:32768
    ds_read_b64_tr_b16 a[34:35], v20 offset:34816
    ds_read_b64_tr_b16 a[36:37], v21 offset:32768
    ds_read_b64_tr_b16 a[38:39], v21 offset:34816
    ds_read_b64_tr_b16 a[40:41], v22 offset:32768
    ds_read_b64_tr_b16 a[42:43], v22 offset:34816
    ds_read_b64_tr_b16 a[44:45], v23 offset:32768
    ds_read_b64_tr_b16 a[46:47], v23 offset:34816
    v_mfma_f32_16x16x32_bf16 v[32:35], v[48:51], v[128:131], v[32:35]
    ds_read_b128 v[60:63], v6 offset:1664
    v_mfma_f32_16x16x32_bf16 v[28:31], v[48:51], v[68:71], v[28:31]
    ds_read_b64 v[56:57], v5 offset:2176
    ds_read_b64 v[58:59], v5 offset:2184
    v_mfma_f32_16x16x32_bf16 v[24:27], v[48:51], v[44:47], 0
    ds_read_b128 v[128:131], v6 offset:2176
    s_waitcnt lgkmcnt(12)
    s_lshl_b32 s6, s68, 5
    s_add_u32 m0, s23, 0
    s_add_u32 s6, s6, s19
    buffer_load_dwordx4 v16, s[40:43], s6 offen offset:0 lds
    buffer_load_dwordx4 v17, s[40:43], s6 offen offset:1024 lds
    buffer_load_dwordx4 v18, s[40:43], s6 offen offset:2048 lds
    buffer_load_dwordx4 v19, s[40:43], s6 offen offset:3072 lds
    s_waitcnt lgkmcnt(4)
    s_lshl_b32 s6, s69, 5
    s_add_u32 m0, s23, 32768
    s_add_u32 s6, s6, s19
    buffer_load_dwordx4 v16, s[40:43], s6 offen offset:0 lds
    buffer_load_dwordx4 v17, s[40:43], s6 offen offset:1024 lds
    buffer_load_dwordx4 v18, s[40:43], s6 offen offset:2048 lds
    buffer_load_dwordx4 v19, s[40:43], s6 offen offset:3072 lds
    v_mfma_f32_16x16x32_bf16 v[36:39], v[64:67], v[72:75], v[36:39]
    ds_read_b64 v[68:69], v5 offset:2688
    ds_read_b64 v[70:71], v5 offset:2696
    v_mfma_f32_16x16x32_bf16 v[36:39], v[136:139], v[132:135], v[36:39]
    ds_read_b128 v[48:51], v6 offset:2688
    s_waitcnt lgkmcnt(6)
    v_mfma_f32_16x16x32_bf16 v[36:39], v[52:55], v[40:43], v[36:39]
    ds_read_b64 v[44:45], v5 offset:3200
    ds_read_b64 v[46:47], v5 offset:3208
    v_mfma_f32_16x16x32_bf16 v[36:39], v[140:143], v[60:63], v[36:39]
    ds_read_b128 v[64:67], v6 offset:3200
    s_waitcnt lgkmcnt(6)
    v_mfma_f32_16x16x32_bf16 v[32:35], v[140:143], v[72:75], v[32:35]
    ds_read_b64 v[136:137], v5 offset:3712
    ds_read_b64 v[138:139], v5 offset:3720
    v_mfma_f32_16x16x32_bf16 v[36:39], v[56:59], v[128:131], v[36:39]
    ds_read_b128 v[52:55], v6 offset:3712
    v_mfma_f32_16x16x32_bf16 v[32:35], v[56:59], v[132:135], v[32:35]
    ds_read_b64 v[140:141], v5 offset:64
    ds_read_b64 v[142:143], v5 offset:72
    v_mfma_f32_16x16x32_bf16 v[28:31], v[56:59], v[72:75], v[28:31]
    s_waitcnt lgkmcnt(8)
    v_mfma_f32_16x16x32_bf16 v[36:39], v[68:71], v[48:51], v[36:39]
    ds_read_b128 v[56:59], v6 offset:64
    v_mfma_f32_16x16x32_bf16 v[32:35], v[68:71], v[40:43], v[32:35]
    ds_read_b64 v[48:49], v5 offset:576
    ds_read_b64 v[50:51], v5 offset:584
    s_waitcnt lgkmcnt(8)
    v_mfma_f32_16x16x32_bf16 v[28:31], v[68:71], v[132:135], v[28:31]
    v_mfma_f32_16x16x32_bf16 v[36:39], v[44:47], v[64:67], v[36:39]
    ds_read_b128 v[68:71], v6 offset:576
    v_mfma_f32_16x16x32_bf16 v[32:35], v[44:47], v[60:63], v[32:35]
    ds_read_b64 v[132:133], v5 offset:1088
    ds_read_b64 v[134:135], v5 offset:1096
    buffer_load_dword v79, v11, s[44:47], 0 offen sc1
    v_mfma_f32_16x16x32_bf16 v[28:31], v[44:47], v[40:43], v[28:31]
    ds_read_b128 v[64:67], v6 offset:1088
    s_waitcnt lgkmcnt(9)
    v_mfma_f32_16x16x32_bf16 v[36:39], v[136:139], v[52:55], v[36:39]
    ds_read_b64 v[44:45], v5 offset:1600
    ds_read_b64 v[46:47], v5 offset:1608
    v_mfma_f32_16x16x32_bf16 v[32:35], v[136:139], v[128:131], v[32:35]
    ds_read_b128 v[40:43], v6 offset:1600
    v_mfma_f32_16x16x32_bf16 v[28:31], v[136:139], v[60:63], v[28:31]
    ds_read_b64 v[52:53], v5 offset:2112
    ds_read_b64 v[54:55], v5 offset:2120
    v_mfma_f32_16x16x32_bf16 v[24:27], v[136:139], v[72:75], v[24:27]
    ds_read_b128 v[128:131], v6 offset:2112
    s_waitcnt lgkmcnt(9)
    v_mfma_f32_16x16x32_bf16 v[36:39], v[140:143], v[56:59], v[36:39]
    ds_read_b64 v[60:61], v5 offset:2624
    ds_read_b64 v[62:63], v5 offset:2632
    s_waitcnt vmcnt(9)
    v_add_u32 v20, 0x10000, v20
    v_add_u32 v21, 0x10000, v21
    v_add_u32 v22, 0x10000, v22
    v_add_u32 v23, 0x10000, v23
    ds_read_b64_tr_b16 a[48:49], v20 offset:0
    ds_read_b64_tr_b16 a[50:51], v20 offset:2048
    ds_read_b64_tr_b16 a[52:53], v21 offset:0
    ds_read_b64_tr_b16 a[54:55], v21 offset:2048
    ds_read_b64_tr_b16 a[56:57], v22 offset:0
    ds_read_b64_tr_b16 a[58:59], v22 offset:2048
    ds_read_b64_tr_b16 a[60:61], v23 offset:0
    ds_read_b64_tr_b16 a[62:63], v23 offset:2048
    v_mfma_f32_16x16x32_bf16 v[36:39], v[48:51], v[68:71], v[36:39]
    ds_read_b128 v[136:139], v6 offset:2624
    s_waitcnt lgkmcnt(14)
    v_mfma_f32_16x16x32_bf16 v[36:39], v[132:135], v[64:67], v[36:39]
    ds_read_b64 v[72:73], v5 offset:3136
    ds_read_b64 v[74:75], v5 offset:3144
    v_mfma_f32_16x16x32_bf16 v[36:39], v[44:47], v[40:43], v[36:39]
    ds_read_b128 v[140:143], v6 offset:3136
    s_waitcnt lgkmcnt(4)
    s_lshl_b32 s6, s70, 5
    s_add_u32 m0, s23, 65536
    s_add_u32 s6, s6, s19
    buffer_load_dwordx4 v16, s[40:43], s6 offen offset:0 lds
    buffer_load_dwordx4 v17, s[40:43], s6 offen offset:1024 lds
    buffer_load_dwordx4 v18, s[40:43], s6 offen offset:2048 lds
    buffer_load_dwordx4 v19, s[40:43], s6 offen offset:3072 lds
    v_mfma_f32_16x16x32_bf16 v[32:35], v[44:47], v[56:59], v[32:35]
    ds_read_b64 v[48:49], v5 offset:3648
    ds_read_b64 v[50:51], v5 offset:3656
    v_mfma_f32_16x16x32_bf16 v[36:39], v[52:55], v[128:131], v[36:39]
    ds_read_b128 v[132:135], v6 offset:3648
    v_mfma_f32_16x16x32_bf16 v[32:35], v[52:55], v[68:71], v[32:35]
    ds_read_b64 v[44:45], v5 offset:0
    ds_read_b64 v[46:47], v5 offset:8
    v_mfma_f32_16x16x32_bf16 v[28:31], v[52:55], v[56:59], v[28:31]
    s_waitcnt lgkmcnt(8)
    v_mfma_f32_16x16x32_bf16 v[36:39], v[60:63], v[136:139], v[36:39]
    ds_read_b128 v[52:55], v6 offset:0
    v_mfma_f32_16x16x32_bf16 v[32:35], v[60:63], v[64:67], v[32:35]
    ds_read_b64 v[136:137], v5 offset:512
    ds_read_b64 v[138:139], v5 offset:520
    s_waitcnt lgkmcnt(8)
    v_mfma_f32_16x16x32_bf16 v[28:31], v[60:63], v[68:71], v[28:31]
    s_waitcnt vmcnt(4)
    s_mov_b32 s61, 0
Ltc2:
    v_cmp_ne_u32 vcc, s60, v79
    s_cbranch_vccz Ltco2
    s_add_u32 s61, s61, 1
    s_cmp_gt_u32 s61, 20000
    s_cbranch_scc1 Ltco2
    buffer_load_dword v79, v11, s[44:47], 0 offen sc1
    s_waitcnt vmcnt(0)
    s_branch Ltc2
Ltco2:
    v_mfma_f32_16x16x32_bf16 v[36:39], v[72:75], v[140:143], v[36:39]
    ds_read_b128 v[60:63], v6 offset:512
    buffer_load_dwordx4 v[80:83], v2, s[44:47], s64 offen sc1
    v_mfma_f32_16x16x32_bf16 v[32:35], v[72:75], v[40:43], v[32:35]
    ds_read_b64 v[68:69], v5 offset:1024
    ds_read_b64 v[70:71], v5 offset:1032
    buffer_load_dwordx4 v[84:87], v13, s[44:47], s64 offen sc1
    v_mfma_f32_16x16x32_bf16 v[28:31], v[72:75], v[64:67], v[28:31]
    ds_read_b128 v[140:143], v6 offset:1024
    buffer_load_dwordx4 v[88:91], v14, s[44:47], s64 offen sc1
    s_waitcnt lgkmcnt(9)
    v_mfma_f32_16x16x32_bf16 v[36:39], v[48:51], v[132:135], v[36:39]
    ds_read_b64 v[72:73], v5 offset:1536
    ds_read_b64 v[74:75], v5 offset:1544
    buffer_load_dwordx4 v[92:95], v15, s[44:47], s64 offen sc1
    v_mfma_f32_16x16x32_bf16 v[32:35], v[48:51], v[128:131], v[32:35]
    ds_read_b128 v[64:67], v6 offset:1536
    buffer_load_dwordx4 v[96:99], v2, s[44:47], s65 offen sc1
    v_mfma_f32_16x16x32_bf16 v[28:31], v[48:51], v[40:43], v[28:31]
    ds_read_b64 v[132:133], v5 offset:2048
    ds_read_b64 v[134:135], v5 offset:2056
    buffer_load_dwordx4 v[100:103], v13, s[44:47], s65 offen sc1
    v_mfma_f32_16x16x32_bf16 v[24:27], v[48:51], v[56:59], v[24:27]
    ds_read_b128 v[128:131], v6 offset:2048
    buffer_load_dwordx4 v[104:107], v14, s[44:47], s65 offen sc1
    s_waitcnt lgkmcnt(9)
    v_mfma_f32_16x16x32_bf16 v[36:39], v[44:47], v[52:55], v[36:39]
    ds_read_b64 v[40:41], v5 offset:2560
    ds_read_b64 v[42:43], v5 offset:2568
    buffer_load_dwordx4 v[108:111], v15, s[44:47], s65 offen sc1
    v_mfma_f32_16x16x32_bf16 v[36:39], v[136:139], v[60:63], v[36:39]
    ds_read_b128 v[48:51], v6 offset:2560
    buffer_load_dwordx4 v[112:115], v2, s[44:47], s66 offen sc1
    s_waitcnt lgkmcnt(6)
    v_mfma_f32_16x16x32_bf16 v[36:39], v[68:71], v[140:143], v[36:39]
    ds_read_b64 v[56:57], v5 offset:3072
    ds_read_b64 v[58:59], v5 offset:3080
    buffer_load_dwordx4 v[116:119], v13, s[44:47], s66 offen sc1
    v_mfma_f32_16x16x32_bf16 v[36:39], v[72:75], v[64:67], v[36:39]
    ds_read_b128 v[44:47], v6 offset:3072
    buffer_load_dwordx4 v[120:123], v14, s[44:47], s66 offen sc1
    s_waitcnt lgkmcnt(6)
    v_mfma_f32_16x16x32_bf16 v[32:35], v[72:75], v[52:55], v[32:35]
    ds_read_b64 v[136:137], v5 offset:3584
    ds_read_b64 v[138:139], v5 offset:3592
    buffer_load_dwordx4 v[124:127], v15, s[44:47], s66 offen sc1
    v_mfma_f32_16x16x32_bf16 v[36:39], v[132:135], v[128:131], v[36:39]
    ds_read_b128 v[68:71], v6 offset:3584
    v_mfma_f32_16x16x32_bf16 v[32:35], v[132:135], v[60:63], v[32:35]
    v_mfma_f32_16x16x32_bf16 v[28:31], v[132:135], v[52:55], v[28:31]
    s_waitcnt lgkmcnt(6)
    v_mfma_f32_16x16x32_bf16 v[36:39], v[40:43], v[48:51], v[36:39]
    v_mfma_f32_16x16x32_bf16 v[32:35], v[40:43], v[140:143], v[32:35]
    s_waitcnt lgkmcnt(3)
    v_mfma_f32_16x16x32_bf16 v[28:31], v[40:43], v[60:63], v[28:31]
    v_mfma_f32_16x16x32_bf16 v[36:39], v[56:59], v[44:47], v[36:39]
    v_mfma_f32_16x16x32_bf16 v[32:35], v[56:59], v[64:67], v[32:35]
    v_mfma_f32_16x16x32_bf16 v[28:31], v[56:59], v[140:143], v[28:31]
    s_waitcnt lgkmcnt(0)
    v_mfma_f32_16x16x32_bf16 v[36:39], v[136:139], v[68:71], v[36:39]
    v_mfma_f32_16x16x32_bf16 v[32:35], v[136:139], v[128:131], v[32:35]
    v_mfma_f32_16x16x32_bf16 v[28:31], v[136:139], v[64:67], v[28:31]
    v_mfma_f32_16x16x32_bf16 v[24:27], v[136:139], v[52:55], v[24:27]
    ds_read_b64 v[48:49], v7 offset:0
    ds_read_b64 v[50:51], v7 offset:1536
    s_bitcmp1_b32 s52, 0
    s_cbranch_scc1 Lx1_0
    s_nop 1
    ds_write_b128 v9, v[32:35] offset:0
    ds_write_b128 v9, v[36:39] offset:1280
    s_branch Lx2_0
Lx1_0:
    s_nop 3
    ds_write_b128 v9, v[24:27] offset:0
    ds_write_b128 v9, v[28:31] offset:1280
    v_mov_b32 v24, v32
    v_mov_b32 v25, v33
    v_mov_b32 v26, v34
    v_mov_b32 v27, v35
    v_mov_b32 v28, v36
    v_mov_b32 v29, v37
    v_mov_b32 v30, v38
    v_mov_b32 v31, v39
Lx2_0:
    v_add_u32 v20, 0xffff0000, v20
    v_add_u32 v21, 0xffff0000, v21
    v_add_u32 v22, 0xffff0000, v22
    v_add_u32 v23, 0xffff0000, v23
    ds_read_b64_tr_b16 a[64:65], v20 offset:0
    ds_read_b64_tr_b16 a[66:67], v20 offset:2048
    ds_read_b64_tr_b16 a[68:69], v21 offset:0
    ds_read_b64_tr_b16 a[70:71], v21 offset:2048
    ds_read_b64_tr_b16 a[72:73], v22 offset:0
    ds_read_b64_tr_b16 a[74:75], v22 offset:2048
    ds_read_b64_tr_b16 a[76:77], v23 offset:0
    ds_read_b64_tr_b16 a[78:79], v23 offset:2048
    ds_read_b64_tr_b16 a[80:81], v20 offset:32768
    ds_read_b64_tr_b16 a[82:83], v20 offset:34816
    ds_read_b64_tr_b16 a[84:85], v21 offset:32768
    ds_read_b64_tr_b16 a[86:87], v21 offset:34816
    ds_read_b64_tr_b16 a[88:89], v22 offset:32768
    ds_read_b64_tr_b16 a[90:91], v22 offset:34816
    ds_read_b64_tr_b16 a[92:93], v23 offset:32768
    ds_read_b64_tr_b16 a[94:95], v23 offset:34816
    s_waitcnt lgkmcnt(0)
    s_barrier
    ds_write_b128 v8, v[24:27] offset:0
    ds_write_b128 v8, v[28:31] offset:1280
    ds_read_b128 v[40:43], v10 offset:0
    ds_read_b128 v[56:59], v12 offset:0
    ds_read_b128 v[44:47], v10 offset:1280
    ds_read_b128 v[60:63], v12 offset:1280
    v_lshlrev_b32 v64, 16, v48
    v_and_b32 v65, 0xffff0000, v48
    v_mov_b32 v129, v4
    v_lshlrev_b32 v66, 16, v49
    v_and_b32 v67, 0xffff0000, v49
    v_mov_b32 v131, v4
    v_lshlrev_b32 v68, 16, v50
    v_and_b32 v69, 0xffff0000, v50
    v_mov_b32 v133, v4
    v_lshlrev_b32 v70, 16, v51
    v_and_b32 v71, 0xffff0000, v51
    v_mov_b32 v135, v4
    s_waitcnt lgkmcnt(2)
    v_add_f32 v56, v56, v40
    v_add_f32 v57, v57, v41
    v_add_f32 v58, v58, v42
    v_add_f32 v59, v59, v43
    v_fma_f32 v56, v64, s20, v56
    v_fma_f32 v57, v65, s20, v57
    v_fma_f32 v58, v66, s20, v58
    v_fma_f32 v59, v67, s20, v59
    v_cvt_pk_bf16_f32 v128, v56, v57
    v_cvt_pk_bf16_f32 v130, v58, v59
    buffer_store_dwordx4 v[128:131], v2, s[44:47], s72 offen offset:0 sc1
    s_waitcnt lgkmcnt(0)
    v_add_f32 v60, v60, v44
    v_add_f32 v61, v61, v45
    v_add_f32 v62, v62, v46
    v_add_f32 v63, v63, v47
    v_fma_f32 v60, v68, s20, v60
    v_fma_f32 v61, v69, s20, v61
    v_fma_f32 v62, v70, s20, v62
    v_fma_f32 v63, v71, s20, v63
    v_cvt_pk_bf16_f32 v132, v60, v61
    v_cvt_pk_bf16_f32 v134, v62, v63
    buffer_store_dwordx4 v[132:135], v2, s[44:47], s72 offen offset:3072 sc1
    s_branch LJ
LC1:
    ds_read_b64 v[40:41], v5 offset:704
    ds_read_b64 v[42:43], v5 offset:712
    ds_read_b128 v[44:47], v6 offset:192
    ds_read_b64 v[48:49], v5 offset:1216
    ds_read_b64 v[50:51], v5 offset:1224
    ds_read_b128 v[52:55], v6 offset:704
    ds_read_b64 v[56:57], v5 offset:1728
    ds_read_b64 v[58:59], v5 offset:1736
    ds_read_b128 v[60:63], v6 offset:1216
    ds_read_b64 v[64:65], v5 offset:2240
    ds_read_b64 v[66:67], v5 offset:2248
    ds_read_b128 v[68:71], v6 offset:1728
    ds_read_b64 v[72:73], v5 offset:2752
    ds_read_b64 v[74:75], v5 offset:2760
    s_waitcnt lgkmcnt(8)
    v_mfma_f32_16x16x32_bf16 v[36:39], v[40:43], v[44:47], 0
    ds_read_b128 v[128:131], v6 offset:2240
    s_lshl_b32 s6, s66, 5
    s_add_u32 m0, s23, 32768
    s_add_u32 s6, s6, s19
    buffer_load_dwordx4 v16, s[40:43], s6 offen offset:0 lds
    buffer_load_dwordx4 v17, s[40:43], s6 offen offset:1024 lds
    buffer_load_dwordx4 v18, s[40:43], s6 offen offset:2048 lds
    buffer_load_dwordx4 v19, s[40:43], s6 offen offset:3072 lds
    v_mfma_f32_16x16x32_bf16 v[36:39], v[48:51], v[52:55], v[36:39]
    ds_read_b64 v[132:133], v5 offset:3264
    ds_read_b64 v[134:135], v5 offset:3272
    v_add_u32 v20, 0x10000, v20
    v_add_u32 v21, 0x10000, v21
    v_add_u32 v22, 0x10000, v22
    v_add_u32 v23, 0x10000, v23
    ds_read_b64_tr_b16 a[0:1], v20 offset:0
    ds_read_b64_tr_b16 a[2:3], v20 offset:2048
    ds_read_b64_tr_b16 a[4:5], v21 offset:0
    ds_read_b64_tr_b16 a[6:7], v21 offset:2048
    ds_read_b64_tr_b16 a[8:9], v22 offset:0
    ds_read_b64_tr_b16 a[10:11], v22 offset:2048
    ds_read_b64_tr_b16 a[12:13], v23 offset:0
    ds_read_b64_tr_b16 a[14:15], v23 offset:2048
    s_waitcnt lgkmcnt(15)
    v_mfma_f32_16x16x32_bf16 v[32:35], v[48:51], v[44:47], 0
    ds_read_b128 v[136:139], v6 offset:2752
    v_mfma_f32_16x16x32_bf16 v[36:39], v[56:59], v[60:63], v[36:39]
    ds_read_b64 v[140:141], v5 offset:3776
    ds_read_b64 v[142:143], v5 offset:3784
    s_waitcnt lgkmcnt(15)
    v_mfma_f32_16x16x32_bf16 v[32:35], v[56:59], v[52:55], v[32:35]
    ds_read_b128 v[40:43], v6 offset:3264
    s_waitcnt lgkmcnt(4)
    s_lshl_b32 s6, s67, 5
    s_add_u32 m0, s23, 65536
    s_add_u32 s6, s6, s19
    buffer_load_dwordx4 v16, s[40:43], s6 offen offset:0 lds
    buffer_load_dwordx4 v17, s[40:43], s6 offen offset:1024 lds
    buffer_load_dwordx4 v18, s[40:43], s6 offen offset:2048 lds
    buffer_load_dwordx4 v19, s[40:43], s6 offen offset:3072 lds
    v_mfma_f32_16x16x32_bf16 v[36:39], v[64:67], v[68:71], v[36:39]
    ds_read_b64 v[48:49], v5 offset:640
    ds_read_b64 v[50:51], v5 offset:648
    v_mfma_f32_16x16x32_bf16 v[32:35], v[64:67], v[60:63], v[32:35]
    ds_read_b128 v[56:59], v6 offset:128
    v_mfma_f32_16x16x32_bf16 v[36:39], v[72:75], v[128:131], v[36:39]
    ds_read_b64 v[64:65], v5 offset:1152
    ds_read_b64 v[66:67], v5 offset:1160
    v_mfma_f32_16x16x32_bf16 v[32:35], v[72:75], v[68:71], v[32:35]
    v_mfma_f32_16x16x32_bf16 v[28:31], v[72:75], v[44:47], 0
    ds_read_b128 v[68:71], v6 offset:640
    s_waitcnt lgkmcnt(9)
    v_mfma_f32_16x16x32_bf16 v[36:39], v[132:135], v[136:139], v[36:39]
    ds_read_b64 v[72:73], v5 offset:1664
    ds_read_b64 v[74:75], v5 offset:1672
    v_mfma_f32_16x16x32_bf16 v[32:35], v[132:135], v[128:131], v[32:35]
    v_mfma_f32_16x16x32_bf16 v[28:31], v[132:135], v[52:55], v[28:31]
    ds_read_b128 v[128:131], v6 offset:1152
    v_mfma_f32_16x16x32_bf16 v[24:27], v[132:135], v[44:47], 0
    s_waitcnt lgkmcnt(9)
    v_mfma_f32_16x16x32_bf16 v[36:39], v[140:143], v[40:43], v[36:39]
    ds_read_b64 v[132:133], v5 offset:2176
    ds_read_b64 v[134:135], v5 offset:2184
    s_waitcnt vmcnt(8)
    v_add_u32 v20, 0xffff0000, v20
    v_add_u32 v21, 0xffff0000, v21
    v_add_u32 v22, 0xffff0000, v22
    v_add_u32 v23, 0xffff0000, v23
    ds_read_b64_tr_b16 a[16:17], v20 offset:0
    ds_read_b64_tr_b16 a[18:19], v20 offset:2048
    ds_read_b64_tr_b16 a[20:21], v21 offset:0
    ds_read_b64_tr_b16 a[22:23], v21 offset:2048
    ds_read_b64_tr_b16 a[24:25], v22 offset:0
    ds_read_b64_tr_b16 a[26:27], v22 offset:2048
    ds_read_b64_tr_b16 a[28:29], v23 offset:0
    ds_read_b64_tr_b16 a[30:31], v23 offset:2048
    s_waitcnt vmcnt(4)
    ds_read_b64_tr_b16 a[32:33], v20 offset:32768
    ds_read_b64_tr_b16 a[34:35], v20 offset:34816
    ds_read_b64_tr_b16 a[36:37], v21 offset:32768
    ds_read_b64_tr_b16 a[38:39], v21 offset:34816
    ds_read_b64_tr_b16 a[40:41], v22 offset:32768
    ds_read_b64_tr_b16 a[42:43], v22 offset:34816
    ds_read_b64_tr_b16 a[44:45], v23 offset:32768
    ds_read_b64_tr_b16 a[46:47], v23 offset:34816
    v_mfma_f32_16x16x32_bf16 v[32:35], v[140:143], v[136:139], v[32:35]
    ds_read_b128 v[44:47], v6 offset:1664
    v_mfma_f32_16x16x32_bf16 v[28:31], v[140:143], v[60:63], v[28:31]
    ds_read_b64 v[40:41], v5 offset:2688
    ds_read_b64 v[42:43], v5 offset:2696
    v_mfma_f32_16x16x32_bf16 v[24:27], v[140:143], v[52:55], v[24:27]
    ds_read_b128 v[136:139], v6 offset:2176
    s_waitcnt lgkmcnt(12)
    s_lshl_b32 s6, s68, 5
    s_add_u32 m0, s23, 0
    s_add_u32 s6, s6, s19
    buffer_load_dwordx4 v16, s[40:43], s6 offen offset:0 lds
    buffer_load_dwordx4 v17, s[40:43], s6 offen offset:1024 lds
    buffer_load_dwordx4 v18, s[40:43], s6 offen offset:2048 lds
    buffer_load_dwordx4 v19, s[40:43], s6 offen offset:3072 lds
    s_waitcnt lgkmcnt(4)
    s_lshl_b32 s6, s69, 5
    s_add_u32 m0, s23, 32768
    s_add_u32 s6, s6, s19
    buffer_load_dwordx4 v16, s[40:43], s6 offen offset:0 lds
    buffer_load_dwordx4 v17, s[40:43], s6 offen offset:1024 lds
    buffer_load_dwordx4 v18, s[40:43], s6 offen offset:2048 lds
    buffer_load_dwordx4 v19, s[40:43], s6 offen offset:3072 lds
    v_mfma_f32_16x16x32_bf16 v[36:39], v[48:51], v[56:59], v[36:39]
    ds_read_b64 v[60:61], v5 offset:3200
    ds_read_b64 v[62:63], v5 offset:3208
    v_mfma_f32_16x16x32_bf16 v[36:39], v[64:67], v[68:71], v[36:39]
    ds_read_b128 v[140:143], v6 offset:2688
    v_mfma_f32_16x16x32_bf16 v[32:35], v[64:67], v[56:59], v[32:35]
    ds_read_b64 v[52:53], v5 offset:3712
    ds_read_b64 v[54:55], v5 offset:3720
    v_mfma_f32_16x16x32_bf16 v[36:39], v[72:75], v[128:131], v[36:39]
    ds_read_b128 v[48:51], v6 offset:3200
    s_waitcnt lgkmcnt(9)
    v_mfma_f32_16x16x32_bf16 v[32:35], v[72:75], v[68:71], v[32:35]
    ds_read_b64 v[64:65], v5 offset:576
    ds_read_b64 v[66:67], v5 offset:584
    v_mfma_f32_16x16x32_bf16 v[36:39], v[132:135], v[44:47], v[36:39]
    ds_read_b128 v[72:75], v6 offset:64
    s_waitcnt lgkmcnt(9)
    v_mfma_f32_16x16x32_bf16 v[32:35], v[132:135], v[128:131], v[32:35]
    v_mfma_f32_16x16x32_bf16 v[36:39], v[40:43], v[136:139], v[36:39]
    ds_read_b64 v[132:133], v5 offset:1088
    ds_read_b64 v[134:135], v5 offset:1096
    v_mfma_f32_16x16x32_bf16 v[32:35], v[40:43], v[44:47], v[32:35]
    v_mfma_f32_16x16x32_bf16 v[28:31], v[40:43], v[56:59], v[28:31]
    ds_read_b128 v[44:47], v6 offset:576
    s_waitcnt lgkmcnt(9)
    v_mfma_f32_16x16x32_bf16 v[36:39], v[60:63], v[140:143], v[36:39]
    ds_read_b64 v[40:41], v5 offset:1600
    ds_read_b64 v[42:43], v5 offset:1608
    v_mfma_f32_16x16x32_bf16 v[32:35], v[60:63], v[136:139], v[32:35]
    v_mfma_f32_16x16x32_bf16 v[28:31], v[60:63], v[68:71], v[28:31]
    ds_read_b128 v[136:139], v6 offset:1088
    buffer_load_dword v79, v11, s[44:47], 0 offen sc1
    v_mfma_f32_16x16x32_bf16 v[24:27], v[60:63], v[56:59], v[24:27]
    s_waitcnt lgkmcnt(9)
    v_mfma_f32_16x16x32_bf16 v[36:39], v[52:55], v[48:51], v[36:39]
    ds_read_b64 v[60:61], v5 offset:2112
    ds_read_b64 v[62:63], v5 offset:2120
    v_mfma_f32_16x16x32_bf16 v[32:35], v[52:55], v[140:143], v[32:35]
    ds_read_b128 v[56:59], v6 offset:1600
    v_mfma_f32_16x16x32_bf16 v[28:31], v[52:55], v[128:131], v[28:31]
    ds_read_b64 v[48:49], v5 offset:2624
    ds_read_b64 v[50:51], v5 offset:2632
    v_mfma_f32_16x16x32_bf16 v[24:27], v[52:55], v[68:71], v[24:27]
    ds_read_b128 v[140:143], v6 offset:2112
    s_waitcnt lgkmcnt(9)
    v_mfma_f32_16x16x32_bf16 v[36:39], v[64:67], v[72:75], v[36:39]
    ds_read_b64 v[128:129], v5 offset:3136
    ds_read_b64 v[130:131], v5 offset:3144
    s_waitcnt vmcnt(9)
    v_add_u32 v20, 0x10000, v20
    v_add_u32 v21, 0x10000, v21
    v_add_u32 v22, 0x10000, v22
    v_add_u32 v23, 0x10000, v23
    ds_read_b64_tr_b16 a[48:49], v20 offset:0
    ds_read_b64_tr_b16 a[50:51], v20 offset:2048
    ds_read_b64_tr_b16 a[52:53], v21 offset:0
    ds_read_b64_tr_b16 a[54:55], v21 offset:2048
    ds_read_b64_tr_b16 a[56:57], v22 offset:0
    ds_read_b64_tr_b16 a[58:59], v22 offset:2048
    ds_read_b64_tr_b16 a[60:61], v23 offset:0
    ds_read_b64_tr_b16 a[62:63], v23 offset:2048
    v_mfma_f32_16x16x32_bf16 v[36:39], v[132:135], v[44:47], v[36:39]
    ds_read_b128 v[52:55], v6 offset:2624
    s_waitcnt lgkmcnt(15)
    v_mfma_f32_16x16x32_bf16 v[32:35], v[132:135], v[72:75], v[32:35]
    ds_read_b64 v[68:69], v5 offset:3648
    ds_read_b64 v[70:71], v5 offset:3656
    v_mfma_f32_16x16x32_bf16 v[36:39], v[40:43], v[136:139], v[36:39]
    ds_read_b128 v[64:67], v6 offset:3136
    s_waitcnt lgkmcnt(4)
    s_lshl_b32 s6, s70, 5
    s_add_u32 m0, s23, 65536
    s_add_u32 s6, s6, s19
    buffer_load_dwordx4 v16, s[40:43], s6 offen offset:0 lds
    buffer_load_dwordx4 v17, s[40:43], s6 offen offset:1024 lds
    buffer_load_dwordx4 v18, s[40:43], s6 offen offset:2048 lds
    buffer_load_dwordx4 v19, s[40:43], s6 offen offset:3072 lds
    v_mfma_f32_16x16x32_bf16 v[32:35], v[40:43], v[44:47], v[32:35]
    ds_read_b64 v[132:133], v5 offset:512
    ds_read_b64 v[134:135], v5 offset:520
    v_mfma_f32_16x16x32_bf16 v[36:39], v[60:63], v[56:59], v[36:39]
    ds_read_b128 v[40:43], v6 offset:0
    v_mfma_f32_16x16x32_bf16 v[32:35], v[60:63], v[136:139], v[32:35]
    v_mfma_f32_16x16x32_bf16 v[36:39], v[48:51], v[140:143], v[36:39]
    ds_read_b64 v[60:61], v5 offset:1024
    ds_read_b64 v[62:63], v5 offset:1032
    v_mfma_f32_16x16x32_bf16 v[32:35], v[48:51], v[56:59], v[32:35]
    v_mfma_f32_16x16x32_bf16 v[28:31], v[48:51], v[72:75], v[28:31]
    ds_read_b128 v[56:59], v6 offset:512
    s_waitcnt lgkmcnt(9)
    v_mfma_f32_16x16x32_bf16 v[36:39], v[128:131], v[52:55], v[36:39]
    ds_read_b64 v[48:49], v5 offset:1536
    ds_read_b64 v[50:51], v5 offset:1544
    s_waitcnt vmcnt(4)
    s_mov_b32 s61, 0
Ltc3:
    v_cmp_ne_u32 vcc, s60, v79
    s_cbranch_vccz Ltco3
    s_add_u32 s61, s61, 1
    s_cmp_gt_u32 s61, 20000
    s_cbranch_scc1 Ltco3
    buffer_load_dword v79, v11, s[44:47], 0 offen sc1
    s_waitcnt vmcnt(0)
    s_branch Ltc3
Ltco3:
    v_mfma_f32_16x16x32_bf16 v[32:35], v[128:131], v[140:143], v[32:35]
    buffer_load_dwordx4 v[80:83], v2, s[44:47], s64 offen sc1
    v_mfma_f32_16x16x32_bf16 v[28:31], v[128:131], v[44:47], v[28:31]
    ds_read_b128 v[140:143], v6 offset:1024
    buffer_load_dwordx4 v[84:87], v13, s[44:47], s64 offen sc1
    v_mfma_f32_16x16x32_bf16 v[24:27], v[128:131], v[72:75], v[24:27]
    buffer_load_dwordx4 v[88:91], v14, s[44:47], s64 offen sc1
    s_waitcnt lgkmcnt(9)
    v_mfma_f32_16x16x32_bf16 v[36:39], v[68:71], v[64:67], v[36:39]
    ds_read_b64 v[128:129], v5 offset:2048
    ds_read_b64 v[130:131], v5 offset:2056
    buffer_load_dwordx4 v[92:95], v15, s[44:47], s64 offen sc1
    v_mfma_f32_16x16x32_bf16 v[32:35], v[68:71], v[52:55], v[32:35]
    ds_read_b128 v[72:75], v6 offset:1536
    buffer_load_dwordx4 v[96:99], v2, s[44:47], s65 offen sc1
    v_mfma_f32_16x16x32_bf16 v[28:31], v[68:71], v[136:139], v[28:31]
    ds_read_b64 v[64:65], v5 offset:2560
    ds_read_b64 v[66:67], v5 offset:2568
    buffer_load_dwordx4 v[100:103], v13, s[44:47], s65 offen sc1
    v_mfma_f32_16x16x32_bf16 v[24:27], v[68:71], v[44:47], v[24:27]
    ds_read_b128 v[52:55], v6 offset:2048
    buffer_load_dwordx4 v[104:107], v14, s[44:47], s65 offen sc1
    s_waitcnt lgkmcnt(9)
    v_mfma_f32_16x16x32_bf16 v[36:39], v[132:135], v[40:43], v[36:39]
    ds_read_b64 v[136:137], v5 offset:3072
    ds_read_b64 v[138:139], v5 offset:3080
    buffer_load_dwordx4 v[108:111], v15, s[44:47], s65 offen sc1
    v_mfma_f32_16x16x32_bf16 v[36:39], v[60:63], v[56:59], v[36:39]
    ds_read_b128 v[68:71], v6 offset:2560
    buffer_load_dwordx4 v[112:115], v2, s[44:47], s66 offen sc1
    s_waitcnt lgkmcnt(9)
    v_mfma_f32_16x16x32_bf16 v[32:35], v[60:63], v[40:43], v[32:35]
    ds_read_b64 v[44:45], v5 offset:3584
    ds_read_b64 v[46:47], v5 offset:3592
    buffer_load_dwordx4 v[116:119], v13, s[44:47], s66 offen sc1
    v_mfma_f32_16x16x32_bf16 v[36:39], v[48:51], v[140:143], v[36:39]
    ds_read_b128 v[132:135], v6 offset:3072
    buffer_load_dwordx4 v[120:123], v14, s[44:47], s66 offen sc1
    s_waitcnt lgkmcnt(9)
    v_mfma_f32_16x16x32_bf16 v[32:35], v[48:51], v[56:59], v[32:35]
    buffer_load_dwordx4 v[124:127], v15, s[44:47], s66 offen sc1
    v_mfma_f32_16x16x32_bf16 v[36:39], v[128:131], v[72:75], v[36:39]
    s_waitcnt lgkmcnt(6)
    v_mfma_f32_16x16x32_bf16 v[32:35], v[128:131], v[140:143], v[32:35]
    v_mfma_f32_16x16x32_bf16 v[36:39], v[64:67], v[52:55], v[36:39]
    v_mfma_f32_16x16x32_bf16 v[32:35], v[64:67], v[72:75], v[32:35]
    v_mfma_f32_16x16x32_bf16 v[28:31], v[64:67], v[40:43], v[28:31]
    s_waitcnt lgkmcnt(3)
    v_mfma_f32_16x16x32_bf16 v[36:39], v[136:139], v[68:71], v[36:39]
    v_mfma_f32_16x16x32_bf16 v[32:35], v[136:139], v[52:55], v[32:35]
    v_mfma_f32_16x16x32_bf16 v[28:31], v[136:139], v[56:59], v[28:31]
    v_mfma_f32_16x16x32_bf16 v[24:27], v[136:139], v[40:43], v[24:27]
    s_waitcnt lgkmcnt(0)
    v_mfma_f32_16x16x32_bf16 v[36:39], v[44:47], v[132:135], v[36:39]
    v_mfma_f32_16x16x32_bf16 v[32:35], v[44:47], v[68:71], v[32:35]
    v_mfma_f32_16x16x32_bf16 v[28:31], v[44:47], v[140:143], v[28:31]
    v_mfma_f32_16x16x32_bf16 v[24:27], v[44:47], v[56:59], v[24:27]
    ds_read_b64 v[48:49], v7 offset:512
    ds_read_b64 v[50:51], v7 offset:1024
    s_bitcmp1_b32 s52, 0
    s_cbranch_scc1 Lx1_1
    s_nop 1
    ds_write_b128 v9, v[32:35] offset:0
    ds_write_b128 v9, v[36:39] offset:1280
    s_branch Lx2_1
Lx1_1:
    s_nop 3
    ds_write_b128 v9, v[24:27] offset:0
    ds_write_b128 v9, v[28:31] offset:1280
    v_mov_b32 v24, v32
    v_mov_b32 v25, v33
    v_mov_b32 v26, v34
    v_mov_b32 v27, v35
    v_mov_b32 v28, v36
    v_mov_b32 v29, v37
    v_mov_b32 v30, v38
    v_mov_b32 v31, v39
Lx2_1:
    v_add_u32 v20, 0xffff0000, v20
    v_add_u32 v21, 0xffff0000, v21
    v_add_u32 v22, 0xffff0000, v22
    v_add_u32 v23, 0xffff0000, v23
    ds_read_b64_tr_b16 a[64:65], v20 offset:0
    ds_read_b64_tr_b16 a[66:67], v20 offset:2048
    ds_read_b64_tr_b16 a[68:69], v21 offset:0
    ds_read_b64_tr_b16 a[70:71], v21 offset:2048
    ds_read_b64_tr_b16 a[72:73], v22 offset:0
    ds_read_b64_tr_b16 a[74:75], v22 offset:2048
    ds_read_b64_tr_b16 a[76:77], v23 offset:0
    ds_read_b64_tr_b16 a[78:79], v23 offset:2048
    ds_read_b64_tr_b16 a[80:81], v20 offset:32768
    ds_read_b64_tr_b16 a[82:83], v20 offset:34816
    ds_read_b64_tr_b16 a[84:85], v21 offset:32768
    ds_read_b64_tr_b16 a[86:87], v21 offset:34816
    ds_read_b64_tr_b16 a[88:89], v22 offset:32768
    ds_read_b64_tr_b16 a[90:91], v22 offset:34816
    ds_read_b64_tr_b16 a[92:93], v23 offset:32768
    ds_read_b64_tr_b16 a[94:95], v23 offset:34816
    s_waitcnt lgkmcnt(0)
    s_barrier
    ds_write_b128 v8, v[24:27] offset:0
    ds_write_b128 v8, v[28:31] offset:1280
    ds_read_b128 v[40:43], v10 offset:0
    ds_read_b128 v[56:59], v12 offset:0
    ds_read_b128 v[44:47], v10 offset:1280
    ds_read_b128 v[60:63], v12 offset:1280
    v_lshlrev_b32 v64, 16, v48
    v_and_b32 v65, 0xffff0000, v48
    v_mov_b32 v129, v4
    v_lshlrev_b32 v66, 16, v49
    v_and_b32 v67, 0xffff0000, v49
    v_mov_b32 v131, v4
    v_lshlrev_b32 v68, 16, v50
    v_and_b32 v69, 0xffff0000, v50
    v_mov_b32 v133, v4
    v_lshlrev_b32 v70, 16, v51
    v_and_b32 v71, 0xffff0000, v51
    v_mov_b32 v135, v4
    s_waitcnt lgkmcnt(2)
    v_add_f32 v56, v56, v40
    v_add_f32 v57, v57, v41
    v_add_f32 v58, v58, v42
    v_add_f32 v59, v59, v43
    v_fma_f32 v56, v64, s20, v56
    v_fma_f32 v57, v65, s20, v57
    v_fma_f32 v58, v66, s20, v58
    v_fma_f32 v59, v67, s20, v59
    v_cvt_pk_bf16_f32 v128, v56, v57
    v_cvt_pk_bf16_f32 v130, v58, v59
    buffer_store_dwordx4 v[128:131], v2, s[44:47], s72 offen offset:1024 sc1
    s_waitcnt lgkmcnt(0)
    v_add_f32 v60, v60, v44
    v_add_f32 v61, v61, v45
    v_add_f32 v62, v62, v46
    v_add_f32 v63, v63, v47
    v_fma_f32 v60, v68, s20, v60
    v_fma_f32 v61, v69, s20, v61
    v_fma_f32 v62, v70, s20, v62
    v_fma_f32 v63, v71, s20, v63
    v_cvt_pk_bf16_f32 v132, v60, v61
    v_cvt_pk_bf16_f32 v134, v62, v63
    buffer_store_dwordx4 v[132:135], v2, s[44:47], s72 offen offset:2048 sc1
LJ:
    buffer_load_dwordx4 v[128:131], v2, s[44:47], s67 offen sc1
    s_nop 0
    buffer_load_dwordx4 v[132:135], v13, s[44:47], s67 offen sc1
    buffer_load_dwordx4 v[136:139], v14, s[44:47], s67 offen sc1
    buffer_load_dwordx4 v[140:143], v15, s[44:47], s67 offen sc1
    s_waitcnt vmcnt(18)
    v_add_u32 v20, 0x10000, v20
    v_add_u32 v21, 0x10000, v21
    v_add_u32 v22, 0x10000, v22
    v_add_u32 v23, 0x10000, v23
    ds_read_b64_tr_b16 a[96:97], v20 offset:0
    ds_read_b64_tr_b16 a[98:99], v20 offset:2048
    ds_read_b64_tr_b16 a[100:101], v21 offset:0
    ds_read_b64_tr_b16 a[102:103], v21 offset:2048
    ds_read_b64_tr_b16 a[104:105], v22 offset:0
    ds_read_b64_tr_b16 a[106:107], v22 offset:2048
    ds_read_b64_tr_b16 a[108:109], v23 offset:0
    ds_read_b64_tr_b16 a[110:111], v23 offset:2048
    s_waitcnt lgkmcnt(0)
    s_waitcnt vmcnt(14)
    v_mfma_f32_16x16x32_bf16 v[16:19], a[0:3], v[80:83], 0
    s_lshl_b32 s61, s59, 6
    v_mfma_f32_16x16x32_bf16 v[20:23], a[0:3], v[84:87], 0
    s_lshl_b32 s3, s52, 3
    s_add_u32 s26, s61, s3
    v_mfma_f32_16x16x32_bf16 v[24:27], a[0:3], v[88:91], 0
    v_and_b32 v7, 15, v1
    v_lshrrev_b32 v8, 4, v1
    v_mfma_f32_16x16x32_bf16 v[28:31], a[0:3], v[92:95], 0
    v_lshlrev_b32 v9, 10, v7
    v_lshl_add_u32 v9, v8, 4, v9
    v_mfma_f32_16x16x32_bf16 v[32:35], a[4:7], v[80:83], 0
    s_lshl_b32 s28, s58, 16
    s_lshr_b32 s61, s52, 1
    v_mfma_f32_16x16x32_bf16 v[36:39], a[4:7], v[84:87], 0
    s_lshl_b32 s3, s61, 14
    s_add_u32 s28, s28, s3
    v_mfma_f32_16x16x32_bf16 v[40:43], a[4:7], v[88:91], 0
    s_lshl_b32 s3, s59, 7
    s_add_u32 s28, s28, s3
    v_mfma_f32_16x16x32_bf16 v[44:47], a[4:7], v[92:95], 0
    s_lshl_b32 s3, s73, 6
    s_add_u32 s28, s28, s3
    v_mfma_f32_16x16x32_bf16 v[48:51], a[8:11], v[80:83], 0
    v_lshlrev_b32 v5, 13, v8
    v_mfma_f32_16x16x32_bf16 v[52:55], a[8:11], v[84:87], 0
    v_lshl_add_u32 v5, v7, 4, v5
    s_lshl_b32 s29, s26, 13
    v_mfma_f32_16x16x32_bf16 v[56:59], a[8:11], v[88:91], 0
    s_lshl_b32 s3, s58, 8
    s_add_u32 s29, s29, s3
    v_mfma_f32_16x16x32_bf16 v[60:63], a[8:11], v[92:95], 0
    s_add_u32 s29, s29, 16777216
    s_add_u32 s27, s29, 32768
    v_mfma_f32_16x16x32_bf16 v[64:67], a[12:15], v[80:83], 0
    v_add_u32 v10, s23, v2
    v_add_u32 v12, s13, v2
    v_mfma_f32_16x16x32_bf16 v[68:71], a[12:15], v[84:87], 0
    v_add_u32 v11, 65536, v10
    v_mul_u32_u24 v6, 144, v8
    v_mfma_f32_16x16x32_bf16 v[72:75], a[12:15], v[88:91], 0
    v_lshl_add_u32 v6, v7, 3, v6
    s_mul_i32 s61, s52, 1152
    v_mfma_f32_16x16x32_bf16 v[76:79], a[12:15], v[92:95], 0
    s_add_u32 s61, s61, 32768
    v_add_u32 v6, s61, v6
    buffer_load_dwordx4 v[80:83], v2, s[44:47], s68 offen sc1
    buffer_load_dwordx4 v[84:87], v13, s[44:47], s68 offen sc1
    buffer_load_dwordx4 v[88:91], v14, s[44:47], s68 offen sc1
    buffer_load_dwordx4 v[92:95], v15, s[44:47], s68 offen sc1
    s_waitcnt vmcnt(14)
    v_mfma_f32_16x16x32_bf16 v[16:19], a[16:19], v[96:99], v[16:19]
    v_mfma_f32_16x16x32_bf16 v[20:23], a[16:19], v[100:103], v[20:23]
    v_mfma_f32_16x16x32_bf16 v[24:27], a[16:19], v[104:107], v[24:27]
    v_mfma_f32_16x16x32_bf16 v[28:31], a[16:19], v[108:111], v[28:31]
    v_mfma_f32_16x16x32_bf16 v[32:35], a[20:23], v[96:99], v[32:35]
    v_mfma_f32_16x16x32_bf16 v[36:39], a[20:23], v[100:103], v[36:39]
    v_mfma_f32_16x16x32_bf16 v[40:43], a[20:23], v[104:107], v[40:43]
    v_mfma_f32_16x16x32_bf16 v[44:47], a[20:23], v[108:111], v[44:47]
    v_mfma_f32_16x16x32_bf16 v[48:51], a[24:27], v[96:99], v[48:51]
    v_mfma_f32_16x16x32_bf16 v[52:55], a[24:27], v[100:103], v[52:55]
    v_mfma_f32_16x16x32_bf16 v[56:59], a[24:27], v[104:107], v[56:59]
    v_mfma_f32_16x16x32_bf16 v[60:63], a[24:27], v[108:111], v[60:63]
    v_mfma_f32_16x16x32_bf16 v[64:67], a[28:31], v[96:99], v[64:67]
    v_mfma_f32_16x16x32_bf16 v[68:71], a[28:31], v[100:103], v[68:71]
    v_mfma_f32_16x16x32_bf16 v[72:75], a[28:31], v[104:107], v[72:75]
    v_mfma_f32_16x16x32_bf16 v[76:79], a[28:31], v[108:111], v[76:79]
    buffer_load_dwordx4 v[96:99], v2, s[44:47], s69 offen sc1
    buffer_load_dwordx4 v[100:103], v13, s[44:47], s69 offen sc1
    buffer_load_dwordx4 v[104:107], v14, s[44:47], s69 offen sc1
    buffer_load_dwordx4 v[108:111], v15, s[44:47], s69 offen sc1
    s_waitcnt vmcnt(14)
    v_mfma_f32_16x16x32_bf16 v[16:19], a[32:35], v[112:115], v[16:19]
    v_mfma_f32_16x16x32_bf16 v[20:23], a[32:35], v[116:119], v[20:23]
    v_mfma_f32_16x16x32_bf16 v[24:27], a[32:35], v[120:123], v[24:27]
    v_mfma_f32_16x16x32_bf16 v[28:31], a[32:35], v[124:127], v[28:31]
    v_mfma_f32_16x16x32_bf16 v[32:35], a[36:39], v[112:115], v[32:35]
    v_mfma_f32_16x16x32_bf16 v[36:39], a[36:39], v[116:119], v[36:39]
    v_mfma_f32_16x16x32_bf16 v[40:43], a[36:39], v[120:123], v[40:43]
    v_mfma_f32_16x16x32_bf16 v[44:47], a[36:39], v[124:127], v[44:47]
    v_mfma_f32_16x16x32_bf16 v[48:51], a[40:43], v[112:115], v[48:51]
    v_mfma_f32_16x16x32_bf16 v[52:55], a[40:43], v[116:119], v[52:55]
    v_mfma_f32_16x16x32_bf16 v[56:59], a[40:43], v[120:123], v[56:59]
    v_mfma_f32_16x16x32_bf16 v[60:63], a[40:43], v[124:127], v[60:63]
    v_mfma_f32_16x16x32_bf16 v[64:67], a[44:47], v[112:115], v[64:67]
    v_mfma_f32_16x16x32_bf16 v[68:71], a[44:47], v[116:119], v[68:71]
    v_mfma_f32_16x16x32_bf16 v[72:75], a[44:47], v[120:123], v[72:75]
    v_mfma_f32_16x16x32_bf16 v[76:79], a[44:47], v[124:127], v[76:79]
    buffer_load_dwordx4 v[112:115], v2, s[44:47], s70 offen sc1
    buffer_load_dwordx4 v[116:119], v13, s[44:47], s70 offen sc1
    buffer_load_dwordx4 v[120:123], v14, s[44:47], s70 offen sc1
    buffer_load_dwordx4 v[124:127], v15, s[44:47], s70 offen sc1
    s_waitcnt vmcnt(12)
    v_mfma_f32_16x16x32_bf16 v[16:19], a[48:51], v[128:131], v[16:19]
    v_mfma_f32_16x16x32_bf16 v[20:23], a[48:51], v[132:135], v[20:23]
    v_mfma_f32_16x16x32_bf16 v[24:27], a[48:51], v[136:139], v[24:27]
    v_mfma_f32_16x16x32_bf16 v[28:31], a[48:51], v[140:143], v[28:31]
    v_mfma_f32_16x16x32_bf16 v[32:35], a[52:55], v[128:131], v[32:35]
    v_mfma_f32_16x16x32_bf16 v[36:39], a[52:55], v[132:135], v[36:39]
    v_mfma_f32_16x16x32_bf16 v[40:43], a[52:55], v[136:139], v[40:43]
    v_mfma_f32_16x16x32_bf16 v[44:47], a[52:55], v[140:143], v[44:47]
    v_mfma_f32_16x16x32_bf16 v[48:51], a[56:59], v[128:131], v[48:51]
    v_mfma_f32_16x16x32_bf16 v[52:55], a[56:59], v[132:135], v[52:55]
    v_mfma_f32_16x16x32_bf16 v[56:59], a[56:59], v[136:139], v[56:59]
    v_mfma_f32_16x16x32_bf16 v[60:63], a[56:59], v[140:143], v[60:63]
    v_mfma_f32_16x16x32_bf16 v[64:67], a[60:63], v[128:131], v[64:67]
    v_mfma_f32_16x16x32_bf16 v[68:71], a[60:63], v[132:135], v[68:71]
    v_mfma_f32_16x16x32_bf16 v[72:75], a[60:63], v[136:139], v[72:75]
    v_mfma_f32_16x16x32_bf16 v[76:79], a[60:63], v[140:143], v[76:79]
    buffer_load_dwordx4 v[128:131], v9, s[32:35], s28 offen
    buffer_load_dwordx4 v[132:135], v5, s[44:47], s29 offen sc1
    buffer_load_dwordx4 v[140:143], v5, s[44:47], s27 offen sc1
    s_waitcnt vmcnt(11)
    v_mfma_f32_16x16x32_bf16 v[16:19], a[64:67], v[80:83], v[16:19]
    v_lshrrev_b32 v136, 1, v8
    v_mfma_f32_16x16x32_bf16 v[20:23], a[64:67], v[84:87], v[20:23]
    s_lshl_b32 s3, s73, 1
    v_add_u32 v136, s3, v136
    v_mfma_f32_16x16x32_bf16 v[24:27], a[64:67], v[88:91], v[24:27]
    v_cmp_eq_u32 vcc, 3, v136
    v_mfma_f32_16x16x32_bf16 v[28:31], a[64:67], v[92:95], v[28:31]
    v_lshlrev_b32 v136, 15, v136
    v_add_u32 v136, 65536, v136
    v_mfma_f32_16x16x32_bf16 v[32:35], a[68:71], v[80:83], v[32:35]
    v_and_b32 v139, 1, v8
    v_mfma_f32_16x16x32_bf16 v[36:39], a[68:71], v[84:87], v[36:39]
    v_cndmask_b32 v136, v136, v3, vcc
    v_lshl_add_u32 v136, v139, 9, v136
    v_mfma_f32_16x16x32_bf16 v[40:43], a[68:71], v[88:91], v[40:43]
    v_lshl_add_u32 v136, v7, 4, v136
    v_mfma_f32_16x16x32_bf16 v[44:47], a[68:71], v[92:95], v[44:47]
    s_lshr_b32 s61, s52, 1
    s_lshl_b32 s61, s61, 10
    v_mfma_f32_16x16x32_bf16 v[48:51], a[72:75], v[80:83], v[48:51]
    v_add_u32 v136, s61, v136
    v_mfma_f32_16x16x32_bf16 v[52:55], a[72:75], v[84:87], v[52:55]
    v_bfe_u32 v138, v1, 2, 2
    v_lshl_add_u32 v138, v8, 3, v138
    v_mfma_f32_16x16x32_bf16 v[56:59], a[72:75], v[88:91], v[56:59]
    v_mul_u32_u24 v138, 144, v138
    v_mfma_f32_16x16x32_bf16 v[60:63], a[72:75], v[92:95], v[60:63]
    v_and_b32 v139, 3, v1
    v_lshl_add_u32 v138, v139, 3, v138
    v_mfma_f32_16x16x32_bf16 v[64:67], a[76:79], v[80:83], v[64:67]
    s_lshr_b32 s61, s52, 1
    v_mfma_f32_16x16x32_bf16 v[68:71], a[76:79], v[84:87], v[68:71]
    s_lshl_b32 s61, s61, 5
    s_mul_i32 s3, s73, 4608
    v_mfma_f32_16x16x32_bf16 v[72:75], a[76:79], v[88:91], v[72:75]
    s_add_u32 s61, s61, s3
    v_mfma_f32_16x16x32_bf16 v[76:79], a[76:79], v[92:95], v[76:79]
    s_add_u32 s61, s61, 32768
    v_add_u32 v138, s61, v138
    s_waitcnt vmcnt(7)
    v_mfma_f32_16x16x32_bf16 v[16:19], a[80:83], v[96:99], v[16:19]
    v_mfma_f32_16x16x32_bf16 v[20:23], a[80:83], v[100:103], v[20:23]
    v_mfma_f32_16x16x32_bf16 v[24:27], a[80:83], v[104:107], v[24:27]
    v_mfma_f32_16x16x32_bf16 v[28:31], a[80:83], v[108:111], v[28:31]
    v_mfma_f32_16x16x32_bf16 v[32:35], a[84:87], v[96:99], v[32:35]
    v_mfma_f32_16x16x32_bf16 v[36:39], a[84:87], v[100:103], v[36:39]
    v_mfma_f32_16x16x32_bf16 v[40:43], a[84:87], v[104:107], v[40:43]
    v_mfma_f32_16x16x32_bf16 v[44:47], a[84:87], v[108:111], v[44:47]
    v_mfma_f32_16x16x32_bf16 v[48:51], a[88:91], v[96:99], v[48:51]
    v_mfma_f32_16x16x32_bf16 v[52:55], a[88:91], v[100:103], v[52:55]
    v_mfma_f32_16x16x32_bf16 v[56:59], a[88:91], v[104:107], v[56:59]
    v_mfma_f32_16x16x32_bf16 v[60:63], a[88:91], v[108:111], v[60:63]
    v_mfma_f32_16x16x32_bf16 v[64:67], a[92:95], v[96:99], v[64:67]
    v_mfma_f32_16x16x32_bf16 v[68:71], a[92:95], v[100:103], v[68:71]
    v_mfma_f32_16x16x32_bf16 v[72:75], a[92:95], v[104:107], v[72:75]
    v_mfma_f32_16x16x32_bf16 v[76:79], a[92:95], v[108:111], v[76:79]
    s_waitcnt vmcnt(3)
    v_mfma_f32_16x16x32_bf16 v[16:19], a[96:99], v[112:115], v[16:19]
    v_mfma_f32_16x16x32_bf16 v[20:23], a[96:99], v[116:119], v[20:23]
    v_mfma_f32_16x16x32_bf16 v[24:27], a[96:99], v[120:123], v[24:27]
    v_mfma_f32_16x16x32_bf16 v[28:31], a[96:99], v[124:127], v[28:31]
    v_mfma_f32_16x16x32_bf16 v[32:35], a[100:103], v[112:115], v[32:35]
    v_mfma_f32_16x16x32_bf16 v[36:39], a[100:103], v[116:119], v[36:39]
    v_mfma_f32_16x16x32_bf16 v[40:43], a[100:103], v[120:123], v[40:43]
    s_nop 1
    ds_write_b128 v10, v[16:19] offset:0
    v_mfma_f32_16x16x32_bf16 v[44:47], a[100:103], v[124:127], v[44:47]
    ds_write_b128 v10, v[20:23] offset:1024
    v_mfma_f32_16x16x32_bf16 v[48:51], a[104:107], v[112:115], v[48:51]
    ds_write_b128 v10, v[24:27] offset:2048
    v_mfma_f32_16x16x32_bf16 v[52:55], a[104:107], v[116:119], v[52:55]
    ds_write_b128 v10, v[28:31] offset:3072
    v_mfma_f32_16x16x32_bf16 v[56:59], a[104:107], v[120:123], v[56:59]
    ds_write_b128 v10, v[32:35] offset:32768
    v_mfma_f32_16x16x32_bf16 v[60:63], a[104:107], v[124:127], v[60:63]
    ds_write_b128 v10, v[36:39] offset:33792
    v_mfma_f32_16x16x32_bf16 v[64:67], a[108:111], v[112:115], v[64:67]
    ds_write_b128 v10, v[40:43] offset:34816
    v_mfma_f32_16x16x32_bf16 v[68:71], a[108:111], v[116:119], v[68:71]
    ds_write_b128 v10, v[44:47] offset:35840
    v_mfma_f32_16x16x32_bf16 v[72:75], a[108:111], v[120:123], v[72:75]
    ds_write_b128 v11, v[48:51] offset:0
    v_mfma_f32_16x16x32_bf16 v[76:79], a[108:111], v[124:127], v[76:79]
    ds_write_b128 v11, v[52:55] offset:1024
    ds_write_b128 v11, v[56:59] offset:2048
    ds_write_b128 v11, v[60:63] offset:3072
    ds_write_b128 v12, v[64:67] offset:0
    ds_write_b128 v12, v[68:71] offset:1024
    s_nop 0
    ds_write_b128 v12, v[72:75] offset:2048
    s_nop 0
    ds_write_b128 v12, v[76:79] offset:3072
    s_waitcnt vmcnt(0)
    s_mov_b32 s61, 0
Ltc4:
    v_xor_b32 v14, v133, v4
    v_xor_b32 v15, v135, v4
    v_or_b32 v14, v14, v15
    v_xor_b32 v15, v141, v4
    v_or_b32 v14, v14, v15
    v_xor_b32 v15, v143, v4
    v_or_b32 v14, v14, v15
    v_cmp_ne_u32 vcc, 0, v14
    s_cbranch_vccz Ltco4
    s_add_u32 s61, s61, 1
    s_cmp_gt_u32 s61, 20000
    s_cbranch_scc1 Ltco4
    buffer_load_dwordx4 v[132:135], v5, s[44:47], s29 offen sc1
    buffer_load_dwordx4 v[140:143], v5, s[44:47], s27 offen sc1
    s_waitcnt vmcnt(0)
    s_branch Ltc4
Ltco4:
    ds_write2_b32 v6, v132, v134 offset0:0 offset1:1
    ds_write2_b32 v6, v140, v142 offset0:144 offset1:145
    s_waitcnt lgkmcnt(0)
    s_barrier
    ds_read_b128 v[16:19], v136 offset:0
    ds_read_b128 v[20:23], v136 offset:256
    ds_read_b128 v[24:27], v136 offset:4096
    ds_read_b128 v[28:31], v136 offset:4352
    ds_read_b128 v[32:35], v136 offset:8192
    ds_read_b128 v[36:39], v136 offset:8448
    ds_read_b128 v[40:43], v136 offset:12288
    ds_read_b128 v[44:47], v136 offset:12544
    ds_read_b128 v[48:51], v136 offset:16384
    ds_read_b128 v[52:55], v136 offset:16640
    ds_read_b128 v[56:59], v136 offset:20480
    ds_read_b128 v[60:63], v136 offset:20736
    ds_read_b128 v[64:67], v136 offset:24576
    ds_read_b128 v[68:71], v136 offset:24832
    ds_read_b128 v[72:75], v136 offset:28672
    ds_read_b128 v[76:79], v136 offset:28928
    ds_read_b64_tr_b16 v[88:89], v138 offset:0
    ds_read_b64_tr_b16 v[90:91], v138 offset:576
    v_lshlrev_b32 v92, 16, v128
    v_and_b32 v93, 0xffff0000, v128
    v_lshlrev_b32 v94, 16, v129
    v_and_b32 v95, 0xffff0000, v129
    v_lshlrev_b32 v96, 16, v130
    v_and_b32 v97, 0xffff0000, v130
    v_lshlrev_b32 v98, 16, v131
    v_and_b32 v99, 0xffff0000, v131
    s_waitcnt lgkmcnt(14)
    v_pk_add_f32 v[16:17], v[16:17], v[24:25]
    v_pk_add_f32 v[18:19], v[18:19], v[26:27]
    v_pk_add_f32 v[20:21], v[20:21], v[28:29]
    v_pk_add_f32 v[22:23], v[22:23], v[30:31]
    s_waitcnt lgkmcnt(12)
    v_pk_add_f32 v[16:17], v[16:17], v[32:33]
    v_pk_add_f32 v[18:19], v[18:19], v[34:35]
    v_pk_add_f32 v[20:21], v[20:21], v[36:37]
    v_pk_add_f32 v[22:23], v[22:23], v[38:39]
    s_waitcnt lgkmcnt(10)
    v_pk_add_f32 v[16:17], v[16:17], v[40:41]
    v_pk_add_f32 v[18:19], v[18:19], v[42:43]
    v_pk_add_f32 v[20:21], v[20:21], v[44:45]
    v_pk_add_f32 v[22:23], v[22:23], v[46:47]
    s_waitcnt lgkmcnt(8)
    v_pk_add_f32 v[16:17], v[16:17], v[48:49]
    v_pk_add_f32 v[18:19], v[18:19], v[50:51]
    v_pk_add_f32 v[20:21], v[20:21], v[52:53]
    v_pk_add_f32 v[22:23], v[22:23], v[54:55]
    s_waitcnt lgkmcnt(6)
    v_pk_add_f32 v[16:17], v[16:17], v[56:57]
    v_pk_add_f32 v[18:19], v[18:19], v[58:59]
    v_pk_add_f32 v[20:21], v[20:21], v[60:61]
    v_pk_add_f32 v[22:23], v[22:23], v[62:63]
    s_waitcnt lgkmcnt(4)
    v_pk_add_f32 v[16:17], v[16:17], v[64:65]
    v_pk_add_f32 v[18:19], v[18:19], v[66:67]
    v_pk_add_f32 v[20:21], v[20:21], v[68:69]
    v_pk_add_f32 v[22:23], v[22:23], v[70:71]
    s_waitcnt lgkmcnt(2)
    v_pk_add_f32 v[16:17], v[16:17], v[72:73]
    v_pk_add_f32 v[18:19], v[18:19], v[74:75]
    v_pk_add_f32 v[20:21], v[20:21], v[76:77]
    v_pk_add_f32 v[22:23], v[22:23], v[78:79]
    v_mul_f32 v24, 0xbfb8aa3b, v16
    v_mul_f32 v25, 0xbfb8aa3b, v17
    v_mul_f32 v26, 0xbfb8aa3b, v18
    v_mul_f32 v27, 0xbfb8aa3b, v19
    v_mul_f32 v28, 0xbfb8aa3b, v20
    v_mul_f32 v29, 0xbfb8aa3b, v21
    v_mul_f32 v30, 0xbfb8aa3b, v22
    v_mul_f32 v31, 0xbfb8aa3b, v23
    v_exp_f32 v24, v24
    v_exp_f32 v25, v25
    v_exp_f32 v26, v26
    v_exp_f32 v27, v27
    v_exp_f32 v28, v28
    v_exp_f32 v29, v29
    v_exp_f32 v30, v30
    v_exp_f32 v31, v31
    s_waitcnt lgkmcnt(0)
    v_lshlrev_b32 v100, 16, v88
    v_and_b32 v101, 0xffff0000, v88
    v_lshlrev_b32 v102, 16, v89
    v_and_b32 v103, 0xffff0000, v89
    v_lshlrev_b32 v104, 16, v90
    v_and_b32 v105, 0xffff0000, v90
    v_lshlrev_b32 v106, 16, v91
    v_and_b32 v107, 0xffff0000, v91
    v_pk_add_f32 v[24:25], v[24:25], 1.0 op_sel_hi:[1,0]
    v_pk_add_f32 v[26:27], v[26:27], 1.0 op_sel_hi:[1,0]
    v_pk_add_f32 v[28:29], v[28:29], 1.0 op_sel_hi:[1,0]
    v_pk_add_f32 v[30:31], v[30:31], 1.0 op_sel_hi:[1,0]
    v_rcp_f32 v24, v24
    v_rcp_f32 v25, v25
    v_rcp_f32 v26, v26
    v_rcp_f32 v27, v27
    v_rcp_f32 v28, v28
    v_rcp_f32 v29, v29
    v_rcp_f32 v30, v30
    v_rcp_f32 v31, v31
    v_pk_mul_f32 v[16:17], v[16:17], v[100:101]
    v_pk_mul_f32 v[18:19], v[18:19], v[102:103]
    v_pk_mul_f32 v[20:21], v[20:21], v[104:105]
    v_pk_mul_f32 v[22:23], v[22:23], v[106:107]
    v_pk_fma_f32 v[16:17], v[16:17], v[24:25], v[92:93]
    v_pk_fma_f32 v[18:19], v[18:19], v[26:27], v[94:95]
    v_pk_fma_f32 v[20:21], v[20:21], v[28:29], v[96:97]
    v_pk_fma_f32 v[22:23], v[22:23], v[30:31], v[98:99]
    v_cvt_pk_bf16_f32 v40, v16, v17
    v_cvt_pk_bf16_f32 v41, v18, v19
    v_cvt_pk_bf16_f32 v42, v20, v21
    v_cvt_pk_bf16_f32 v43, v22, v23
    buffer_store_dwordx4 v[40:43], v9, s[48:51], s28 offen
Lend:
    s_endpgm
.section .rodata,"a"
.p2align 6
.amdhsa_kernel recurrent_scan__ssm_conv_s4d__dense_activation_silu__prompt_kernel
  .amdhsa_next_free_vgpr 256
  .amdhsa_next_free_sgpr 102
  .amdhsa_accum_offset 144
  .amdhsa_group_segment_fixed_size 0
  .amdhsa_kernarg_size 104
  .amdhsa_user_sgpr_count 2
  .amdhsa_user_sgpr_kernarg_segment_ptr 1
  .amdhsa_system_sgpr_workgroup_id_x 1
.end_amdhsa_kernel
```
